```python
import torch

def _softmax(x, axis=-1):
    return torch.softmax(x, dim=axis)
def _gelu(x):
    return torch.nn.functional.gelu(x, approximate="tanh")
def _silu(x):
    return torch.nn.functional.silu(x)
def _sigmoid(x):
    return torch.sigmoid(x)
def _layernorm(x, axis=-1, eps=1e-5):
    m = x.mean(dim=axis, keepdim=True)
    v = x.var(dim=axis, keepdim=True, unbiased=False)
    return (x - m) / torch.sqrt(v + eps)
def _scatter_add(tgt, idx, src, axis=0):
    return tgt.clone().index_add_(axis, idx, src)
def _segment_sum(src, seg, n):
    out = torch.zeros((n,) + src.shape[1:], dtype=src.dtype)
    return out.index_add_(0, seg, src)
def _pad(x, pw):
    flat = tuple(v for pair in reversed(pw) for v in pair)
    return torch.nn.functional.pad(x, flat)

kernel_name = 'concat_heads__gqa_block_cached__compressed_kv_cla__decode'

def setup_inputs():

    _w = (lambda a: (lambda t: t.to(torch.bfloat16) if t.is_floating_point() else t)(torch.as_tensor(a)))
    def _A_setup():
        B, Sq, D = 2, 1, 512
        Hq, Hkv, Sk, Dh = 32, 8, 8192, 128
        assert Hq % Hkv == 0, (Hq, Hkv)
        return {
            "x": _w((lambda *s: torch.randn(*s, dtype=torch.bfloat16) * 1.6)(B, Sq, D)),
            "k_cache": _w((lambda *s: torch.randn(*s, dtype=torch.bfloat16) * 1.6)(B, Hkv, Sk, Dh)),
            "v_cache": _w((lambda *s: torch.randn(*s, dtype=torch.bfloat16) * 0.05)(B, Hkv, Sk, Dh)),
            "wq": _w((lambda *s: torch.randn(*s, dtype=torch.bfloat16) * 1.6)(D, Hq * Dh) * (D ** -0.5)),
            "wo": _w((lambda *s: torch.randn(*s, dtype=torch.bfloat16) * 0.05)(Hq * Dh, D) * ((Hq * Dh) ** -0.5)),
        }
    _A_in = _A_setup()

    def _B_setup():
        B, H, Sq, Sk, D, M = 2, 32, 1, 8192, 128, 512
        Dc = 4 * D
        return {
            "x": _w((lambda *s: torch.randn(*s, dtype=torch.bfloat16) * 3.2)(B, Sq, M)),
            "c_kv": _w((lambda *s: torch.randn(*s, dtype=torch.bfloat16) * 0.1)(B, Sk, Dc)),
            "w_q": _w((lambda *s: torch.randn(*s, dtype=torch.bfloat16) * 6.4)(M, H, D) * (M ** -0.5)),
            "w_uk": _w((lambda *s: torch.randn(*s, dtype=torch.bfloat16) * 6.4)(Dc, H, D) * (Dc ** -0.5)),
            "w_uv": _w((lambda *s: torch.randn(*s, dtype=torch.bfloat16) * 0.1)(Dc, H, D) * (Dc ** -0.5)),
            "w_o": _w((lambda *s: torch.randn(*s, dtype=torch.bfloat16) * 0.1)(H, D, M) * ((H * D) ** -0.5)),
        }
    _B_in = _B_setup()

    return {
        "A_x": _A_in["x"],
        "A_k_cache": _A_in["k_cache"],
        "A_v_cache": _A_in["v_cache"],
        "A_wq": _A_in["wq"],
        "A_wo": _A_in["wo"],
        "B_x": _B_in["x"],
        "B_c_kv": _B_in["c_kv"],
        "B_w_q": _B_in["w_q"],
        "B_w_uk": _B_in["w_uk"],
        "B_w_uv": _B_in["w_uv"],
        "B_w_o": _B_in["w_o"],
    }

def reference(A_x, A_k_cache, A_v_cache, A_wq, A_wo, B_x, B_c_kv, B_w_q, B_w_uk, B_w_uv, B_w_o):
    def _A_ref(x, k_cache, v_cache, wq, wo):
        B, Sq, D = x.shape
        Hq, Dh = 32, 128
        Hkv = k_cache.shape[1]
        rep = Hq // Hkv
        q = (lambda x, *d: x.permute(*d))((x @ wq).reshape(B, Sq, Hq, Dh), 0, 2, 1, 3)
        k = (lambda x, n, axis: torch.repeat_interleave(x, n, dim=axis))(k_cache, rep, axis=1)
        v = (lambda x, n, axis: torch.repeat_interleave(x, n, dim=axis))(v_cache, rep, axis=1)
        scores = torch.einsum("bhqd,bhkd->bhqk", q, k) * (Dh ** -0.5)
        p = _softmax(scores, axis=-1)
        o = torch.einsum("bhqk,bhkd->bhqd", p, v)
        return (lambda x, *d: x.permute(*d))(o, 0, 2, 1, 3).reshape(B, Sq, Hq * Dh) @ wo

    def _B_ref(x, c_kv, w_q, w_uk, w_uv, w_o):
        B, Sq, M = x.shape[0], x.shape[1], x.shape[2]
        Sk = c_kv.shape[1]
        H, D = w_q.shape[1], w_q.shape[2]
        q = torch.einsum("bqm,mhd->bhqd", x, w_q)
        k = torch.einsum("bkc,chd->bhkd", c_kv, w_uk)
        v = torch.einsum("bkc,chd->bhkd", c_kv, w_uv)
        scores = torch.einsum("bhqd,bhkd->bhqk", q, k) * (D ** -0.5)
        off = Sk - Sq
        qi = torch.arange(Sq)[:, None]
        kj = torch.arange(Sk)[None, :]
        cmask = kj <= (qi + off)
        scores = torch.where(cmask[None, None], scores, -1e9)
        p = _softmax(scores, axis=-1)
        ctx = torch.einsum("bhqk,bhkd->bhqd", p, v)
        return torch.einsum("bhqd,hdm->bqm", ctx, w_o)

    a = _A_ref(A_x, A_k_cache, A_v_cache, A_wq, A_wo)
    b = _B_ref(B_x, B_c_kv, B_w_q, B_w_uk, B_w_uv, B_w_o)
    return torch.concatenate([a, b], axis=-1)
```

```asm
; @launch grid=(256,1,1) block=(512,1,1) lds=163840
.amdgcn_target "amdgcn-amd-amdhsa--gfx950"
.text
.globl concat_heads__gqa_block_cached__compressed_kv_cla__decode_kernel
.p2align 8
.type concat_heads__gqa_block_cached__compressed_kv_cla__decode_kernel,@function
concat_heads__gqa_block_cached__compressed_kv_cla__decode_kernel:
    s_load_dwordx16 s[16:31], s[0:1], 0
    s_load_dwordx8 s[32:39], s[0:1], 64
    s_load_dwordx4 s[40:43], s[0:1], 96
    s_cmp_ge_u32 s2, 256
    s_cbranch_scc1 L_end
    v_lshrrev_b32 v1, 6, v0
    s_nop 0
    v_readfirstlane_b32 s3, v1
    v_and_b32 v0, 63, v0
    v_lshrrev_b32 v1, 4, v0
    v_and_b32 v2, 15, v0
    s_mov_b32 s8, 0x05040100
    s_mov_b32 s9, 0x07060302
    s_mov_b32 s10, 0x3e0293ee
    s_mov_b32 s12, 0xffff0000
    s_mov_b32 s13, 0xffff0000
    s_mov_b32 s14, 0
    s_mov_b32 s15, -1
    s_sub_u32 s71, s2, 160
    v_lshrrev_b32 v7, 2, v2
    v_bfe_u32 v8, v2, 1, 1
    v_lshl_add_u32 v15, v7, 3, v8
    v_and_b32 v7, 1, v2
    v_lshlrev_b32 v7, 4, v7
    v_lshl_add_u32 v13, v1, 5, v7
    s_cmp_lt_u32 s2, 128
    s_cbranch_scc1 L_A
    s_cmp_ge_u32 s71, 64
    s_cbranch_scc1 L_H
L_B:
    v_lshrrev_b32 v7, 2, v2
    v_lshlrev_b32 v7, 3, v7
    v_and_b32 v8, 2, v2
    v_add_u32 v8, v7, v8
    v_lshl_add_u32 v3, v8, 10, v13
    v_and_b32 v8, 3, v2
    v_add_u32 v4, v7, v8
    v_lshlrev_b32 v4, 10, v4
    s_lshl_b32 s72, s71, 18
    s_lshl_b32 s5, s3, 15
    s_add_u32 s72, s72, s5
    s_add_u32 s73, s72, 4096
    v_and_b32 v26, 3, v0
    v_lshlrev_b32 v26, 13, v26
    v_add_u32 v26, 131072, v26
    v_mov_b32 v9, -1
    ds_write_b32 v26, v9
    ds_write_b32 v26, v9 offset:8064
    s_waitcnt lgkmcnt(0)
    s_mov_b32 s64, s28
    s_and_b32 s65, s29, 0xffff
    s_mov_b32 s66, 16777216
    s_mov_b32 s67, 0x00020000
    buffer_load_dwordx4 v[64:67], v3, s[64:67], s72 offen offset:0 nt
    buffer_load_dwordx4 v[68:71], v3, s[64:67], s72 offen offset:1024 nt
    buffer_load_dwordx4 v[72:75], v3, s[64:67], s72 offen offset:128 nt
    buffer_load_dwordx4 v[76:79], v3, s[64:67], s72 offen offset:1152 nt
    buffer_load_dwordx4 v[80:83], v3, s[64:67], s72 offen offset:256 nt
    buffer_load_dwordx4 v[84:87], v3, s[64:67], s72 offen offset:1280 nt
    buffer_load_dwordx4 v[88:91], v3, s[64:67], s72 offen offset:384 nt
    buffer_load_dwordx4 v[92:95], v3, s[64:67], s72 offen offset:1408 nt
    buffer_load_dwordx4 v[96:99], v3, s[64:67], s72 offen offset:512 nt
    buffer_load_dwordx4 v[100:103], v3, s[64:67], s72 offen offset:1536 nt
    buffer_load_dwordx4 v[104:107], v3, s[64:67], s72 offen offset:640 nt
    buffer_load_dwordx4 v[108:111], v3, s[64:67], s72 offen offset:1664 nt
    buffer_load_dwordx4 v[112:115], v3, s[64:67], s72 offen offset:768 nt
    buffer_load_dwordx4 v[116:119], v3, s[64:67], s72 offen offset:1792 nt
    buffer_load_dwordx4 v[120:123], v3, s[64:67], s72 offen offset:896 nt
    buffer_load_dwordx4 v[124:127], v3, s[64:67], s72 offen offset:1920 nt
    s_branch L_B_2
L_A:
    v_lshl_add_u32 v3, v15, 8, v13
    v_lshlrev_b32 v7, 11, v1
    v_lshl_add_u32 v4, v2, 4, v7
    s_lshr_b32 s79, s2, 3
    s_and_b32 s70, s2, 7
    s_bfe_u32 s5, s2, 0x40001
    s_and_b32 s6, s2, 1
    s_add_u32 s6, s6, 8
    s_cmp_lt_u32 s2, 128
    s_cselect_b32 s79, s79, s5
    s_cselect_b32 s70, s70, s6
    s_lshl_b32 s74, s79, 21
    s_lshl_b32 s6, s70, 17
    s_add_u32 s6, s6, s74
    s_add_u32 s74, s74, 1310720
    s_add_u32 s5, s3, 6
    s_and_b32 s5, s5, 7
    s_lshl_b32 s5, s5, 13
    s_add_u32 s72, s6, s5
    s_add_u32 s73, s72, 65536
    v_mov_b32 v8, 0
    v_mov_b32 v9, 0
    ds_write_b32 v8, v9
    ds_write_b32 v8, v9 offset:32
    s_waitcnt lgkmcnt(0)
L_A_ns0:
    s_mov_b32 s56, s18
    s_and_b32 s57, s19, 0xffff
    s_mov_b32 s58, 33554432
    s_mov_b32 s59, 0x00020000
    s_mov_b32 s60, s20
    s_and_b32 s61, s21, 0xffff
    s_mov_b32 s62, 33554432
    s_mov_b32 s63, 0x00020000
    s_cmp_ge_u32 s3, 2
    s_cbranch_scc1 L_A_wn
    s_cmp_ge_u32 s2, 128
    s_cbranch_scc1 L_A_p1
L_A_p1go:
    s_cmp_eq_u32 s3, 0
    s_cselect_b32 s48, s30, s22
    s_cselect_b32 s49, s31, s23
    s_cselect_b32 s52, s26, s16
    s_cselect_b32 s53, s27, s17
    s_cselect_b32 s76, 262144, 0
    s_and_b32 s49, s49, 0xffff
    s_mov_b32 s50, 4194304
    s_mov_b32 s51, 0x00020000
    s_and_b32 s53, s53, 0xffff
    s_mov_b32 s54, 2048
    s_mov_b32 s55, 0x00020000
    s_lshr_b32 s68, s2, 2
    s_and_b32 s69, s2, 3
    v_lshlrev_b32 v10, 16, v1
    v_lshl_add_u32 v10, v2, 4, v10
    s_lshl_b32 s5, s69, 20
    s_lshl_b32 s6, s68, 8
    s_add_u32 s5, s5, s6
    v_and_b32 v9, 1, v0
    v_lshlrev_b32 v9, 10, v9
    v_lshl_add_u32 v9, v1, 4, v9
    s_lshl_b32 s6, s69, 8
    s_cmp_eq_u32 s3, 0
    s_cbranch_scc1 L_A_p1a
    s_barrier
    s_and_b32 s7, s2, 15
    s_cmp_lg_u32 s7, 0
    s_cbranch_scc1 L_A_p1a
    s_mov_b32 s44, s42
    s_and_b32 s45, s43, 0xffff
    s_mov_b32 s46, 4718592
    s_mov_b32 s47, 0x00020000
    s_lshl_b32 s7, s2, 4
    s_add_u32 s7, s7, 4096
    v_lshlrev_b32 v11, 11, v0
    v_mov_b32 v12, 0
    s_mov_b64 exec, 3
    buffer_store_dword v12, v11, s[44:47], s7 offen sc1
    buffer_store_dword v12, v11, s[44:47], s7 offen offset:128 sc1
    s_mov_b64 exec, -1
L_A_p1a:
    buffer_load_dwordx4 v[224:227], v9, s[52:55], s6 offen offset:0
    buffer_load_dwordx4 v[228:231], v9, s[52:55], s6 offen offset:64
    buffer_load_dwordx4 v[232:235], v9, s[52:55], s6 offen offset:128
    buffer_load_dwordx4 v[236:239], v9, s[52:55], s6 offen offset:192
    buffer_load_dwordx4 v[64:67], v10, s[48:51], s5 offen nt
    s_add_u32 s5, s5, 8192
    buffer_load_dwordx4 v[68:71], v10, s[48:51], s5 offen nt
    s_add_u32 s5, s5, 8192
    buffer_load_dwordx4 v[72:75], v10, s[48:51], s5 offen nt
    s_add_u32 s5, s5, 8192
    buffer_load_dwordx4 v[76:79], v10, s[48:51], s5 offen nt
    s_add_u32 s5, s5, 8192
    buffer_load_dwordx4 v[80:83], v10, s[48:51], s5 offen nt
    s_add_u32 s5, s5, 8192
    buffer_load_dwordx4 v[84:87], v10, s[48:51], s5 offen nt
    s_add_u32 s5, s5, 8192
    buffer_load_dwordx4 v[88:91], v10, s[48:51], s5 offen nt
    s_add_u32 s5, s5, 8192
    buffer_load_dwordx4 v[92:95], v10, s[48:51], s5 offen nt
    s_add_u32 s5, s5, 204800
    buffer_load_dwordx4 v[96:99], v10, s[48:51], s5 offen nt
    s_add_u32 s5, s5, 8192
    buffer_load_dwordx4 v[100:103], v10, s[48:51], s5 offen nt
    s_add_u32 s5, s5, 8192
    buffer_load_dwordx4 v[104:107], v10, s[48:51], s5 offen nt
    s_add_u32 s5, s5, 8192
    buffer_load_dwordx4 v[108:111], v10, s[48:51], s5 offen nt
    s_add_u32 s5, s5, 8192
    buffer_load_dwordx4 v[112:115], v10, s[48:51], s5 offen nt
    s_add_u32 s5, s5, 8192
    buffer_load_dwordx4 v[116:119], v10, s[48:51], s5 offen nt
    s_add_u32 s5, s5, 8192
    buffer_load_dwordx4 v[120:123], v10, s[48:51], s5 offen nt
    s_add_u32 s5, s5, 8192
    buffer_load_dwordx4 v[124:127], v10, s[48:51], s5 offen nt
    s_add_u32 s5, s5, 204800
    buffer_load_dwordx4 v[128:131], v10, s[48:51], s5 offen nt
    s_add_u32 s5, s5, 8192
    buffer_load_dwordx4 v[132:135], v10, s[48:51], s5 offen nt
    s_add_u32 s5, s5, 8192
    buffer_load_dwordx4 v[136:139], v10, s[48:51], s5 offen nt
    s_add_u32 s5, s5, 8192
    buffer_load_dwordx4 v[140:143], v10, s[48:51], s5 offen nt
    s_add_u32 s5, s5, 8192
    buffer_load_dwordx4 v[144:147], v10, s[48:51], s5 offen nt
    s_add_u32 s5, s5, 8192
    buffer_load_dwordx4 v[148:151], v10, s[48:51], s5 offen nt
    s_add_u32 s5, s5, 8192
    buffer_load_dwordx4 v[152:155], v10, s[48:51], s5 offen nt
    s_add_u32 s5, s5, 8192
    buffer_load_dwordx4 v[156:159], v10, s[48:51], s5 offen nt
    s_add_u32 s5, s5, 204800
    buffer_load_dwordx4 v[160:163], v10, s[48:51], s5 offen nt
    s_add_u32 s5, s5, 8192
    buffer_load_dwordx4 v[164:167], v10, s[48:51], s5 offen nt
    s_add_u32 s5, s5, 8192
    buffer_load_dwordx4 v[168:171], v10, s[48:51], s5 offen nt
    s_add_u32 s5, s5, 8192
    buffer_load_dwordx4 v[172:175], v10, s[48:51], s5 offen nt
    s_add_u32 s5, s5, 8192
    buffer_load_dwordx4 v[176:179], v10, s[48:51], s5 offen nt
    s_add_u32 s5, s5, 8192
    buffer_load_dwordx4 v[180:183], v10, s[48:51], s5 offen nt
    s_add_u32 s5, s5, 8192
    buffer_load_dwordx4 v[184:187], v10, s[48:51], s5 offen nt
    s_add_u32 s5, s5, 8192
    buffer_load_dwordx4 v[188:191], v10, s[48:51], s5 offen nt
    s_cmp_lg_u32 s3, 0
    s_cbranch_scc1 L_A_p1b
    s_barrier
L_A_p1b:
    s_load_dword s4, s[42:43], 0
    s_mov_b32 s44, s42
    s_and_b32 s45, s43, 0xffff
    s_mov_b32 s46, 4718592
    s_mov_b32 s47, 0x00020000
    v_lshlrev_b32 v9, 4, v0
    s_lshl_b32 s6, s2, 11
    s_add_u32 s76, s76, s6
    s_add_u32 s76, s76, 524288
    s_waitcnt vmcnt(24)
    v_perm_b32 v192, v68, v64, s8
    v_perm_b32 v193, v76, v72, s8
    v_perm_b32 v194, v84, v80, s8
    v_perm_b32 v195, v92, v88, s8
    v_perm_b32 v196, v68, v64, s9
    v_perm_b32 v197, v76, v72, s9
    v_perm_b32 v198, v84, v80, s9
    v_perm_b32 v199, v92, v88, s9
    v_perm_b32 v200, v69, v65, s8
    v_perm_b32 v201, v77, v73, s8
    v_perm_b32 v202, v85, v81, s8
    v_perm_b32 v203, v93, v89, s8
    v_perm_b32 v204, v69, v65, s9
    v_perm_b32 v205, v77, v73, s9
    v_perm_b32 v206, v85, v81, s9
    v_perm_b32 v207, v93, v89, s9
    v_perm_b32 v208, v70, v66, s8
    v_perm_b32 v209, v78, v74, s8
    v_perm_b32 v210, v86, v82, s8
    v_perm_b32 v211, v94, v90, s8
    v_perm_b32 v212, v70, v66, s9
    v_perm_b32 v213, v78, v74, s9
    v_perm_b32 v214, v86, v82, s9
    v_perm_b32 v215, v94, v90, s9
    v_perm_b32 v216, v71, v67, s8
    v_perm_b32 v217, v79, v75, s8
    v_perm_b32 v218, v87, v83, s8
    v_perm_b32 v219, v95, v91, s8
    v_perm_b32 v220, v71, v67, s9
    v_perm_b32 v221, v79, v75, s9
    v_perm_b32 v222, v87, v83, s9
    v_perm_b32 v223, v95, v91, s9
    v_mfma_f32_16x16x32_bf16 v[32:35], v[224:227], v[192:195], 0
    v_mfma_f32_16x16x32_bf16 v[36:39], v[224:227], v[196:199], 0
    v_mfma_f32_16x16x32_bf16 v[40:43], v[224:227], v[200:203], 0
    v_mfma_f32_16x16x32_bf16 v[44:47], v[224:227], v[204:207], 0
    v_mfma_f32_16x16x32_bf16 v[48:51], v[224:227], v[208:211], 0
    v_mfma_f32_16x16x32_bf16 v[52:55], v[224:227], v[212:215], 0
    v_mfma_f32_16x16x32_bf16 v[56:59], v[224:227], v[216:219], 0
    v_mfma_f32_16x16x32_bf16 v[60:63], v[224:227], v[220:223], 0
    s_waitcnt vmcnt(16)
    v_perm_b32 v192, v100, v96, s8
    v_perm_b32 v193, v108, v104, s8
    v_perm_b32 v194, v116, v112, s8
    v_perm_b32 v195, v124, v120, s8
    v_perm_b32 v196, v100, v96, s9
    v_perm_b32 v197, v108, v104, s9
    v_perm_b32 v198, v116, v112, s9
    v_perm_b32 v199, v124, v120, s9
    v_perm_b32 v200, v101, v97, s8
    v_perm_b32 v201, v109, v105, s8
    v_perm_b32 v202, v117, v113, s8
    v_perm_b32 v203, v125, v121, s8
    v_perm_b32 v204, v101, v97, s9
    v_perm_b32 v205, v109, v105, s9
    v_perm_b32 v206, v117, v113, s9
    v_perm_b32 v207, v125, v121, s9
    v_perm_b32 v208, v102, v98, s8
    v_perm_b32 v209, v110, v106, s8
    v_perm_b32 v210, v118, v114, s8
    v_perm_b32 v211, v126, v122, s8
    v_perm_b32 v212, v102, v98, s9
    v_perm_b32 v213, v110, v106, s9
    v_perm_b32 v214, v118, v114, s9
    v_perm_b32 v215, v126, v122, s9
    v_perm_b32 v216, v103, v99, s8
    v_perm_b32 v217, v111, v107, s8
    v_perm_b32 v218, v119, v115, s8
    v_perm_b32 v219, v127, v123, s8
    v_perm_b32 v220, v103, v99, s9
    v_perm_b32 v221, v111, v107, s9
    v_perm_b32 v222, v119, v115, s9
    v_perm_b32 v223, v127, v123, s9
    v_mfma_f32_16x16x32_bf16 v[32:35], v[228:231], v[192:195], v[32:35]
    v_mfma_f32_16x16x32_bf16 v[36:39], v[228:231], v[196:199], v[36:39]
    v_mfma_f32_16x16x32_bf16 v[40:43], v[228:231], v[200:203], v[40:43]
    v_mfma_f32_16x16x32_bf16 v[44:47], v[228:231], v[204:207], v[44:47]
    v_mfma_f32_16x16x32_bf16 v[48:51], v[228:231], v[208:211], v[48:51]
    v_mfma_f32_16x16x32_bf16 v[52:55], v[228:231], v[212:215], v[52:55]
    v_mfma_f32_16x16x32_bf16 v[56:59], v[228:231], v[216:219], v[56:59]
    v_mfma_f32_16x16x32_bf16 v[60:63], v[228:231], v[220:223], v[60:63]
    s_waitcnt vmcnt(8)
    v_perm_b32 v192, v132, v128, s8
    v_perm_b32 v193, v140, v136, s8
    v_perm_b32 v194, v148, v144, s8
    v_perm_b32 v195, v156, v152, s8
    v_perm_b32 v196, v132, v128, s9
    v_perm_b32 v197, v140, v136, s9
    v_perm_b32 v198, v148, v144, s9
    v_perm_b32 v199, v156, v152, s9
    v_perm_b32 v200, v133, v129, s8
    v_perm_b32 v201, v141, v137, s8
    v_perm_b32 v202, v149, v145, s8
    v_perm_b32 v203, v157, v153, s8
    v_perm_b32 v204, v133, v129, s9
    v_perm_b32 v205, v141, v137, s9
    v_perm_b32 v206, v149, v145, s9
    v_perm_b32 v207, v157, v153, s9
    v_perm_b32 v208, v134, v130, s8
    v_perm_b32 v209, v142, v138, s8
    v_perm_b32 v210, v150, v146, s8
    v_perm_b32 v211, v158, v154, s8
    v_perm_b32 v212, v134, v130, s9
    v_perm_b32 v213, v142, v138, s9
    v_perm_b32 v214, v150, v146, s9
    v_perm_b32 v215, v158, v154, s9
    v_perm_b32 v216, v135, v131, s8
    v_perm_b32 v217, v143, v139, s8
    v_perm_b32 v218, v151, v147, s8
    v_perm_b32 v219, v159, v155, s8
    v_perm_b32 v220, v135, v131, s9
    v_perm_b32 v221, v143, v139, s9
    v_perm_b32 v222, v151, v147, s9
    v_perm_b32 v223, v159, v155, s9
    v_mfma_f32_16x16x32_bf16 v[32:35], v[232:235], v[192:195], v[32:35]
    v_mfma_f32_16x16x32_bf16 v[36:39], v[232:235], v[196:199], v[36:39]
    v_mfma_f32_16x16x32_bf16 v[40:43], v[232:235], v[200:203], v[40:43]
    v_mfma_f32_16x16x32_bf16 v[44:47], v[232:235], v[204:207], v[44:47]
    v_mfma_f32_16x16x32_bf16 v[48:51], v[232:235], v[208:211], v[48:51]
    v_mfma_f32_16x16x32_bf16 v[52:55], v[232:235], v[212:215], v[52:55]
    v_mfma_f32_16x16x32_bf16 v[56:59], v[232:235], v[216:219], v[56:59]
    v_mfma_f32_16x16x32_bf16 v[60:63], v[232:235], v[220:223], v[60:63]
    s_waitcnt vmcnt(0)
    v_perm_b32 v192, v164, v160, s8
    v_perm_b32 v193, v172, v168, s8
    v_perm_b32 v194, v180, v176, s8
    v_perm_b32 v195, v188, v184, s8
    v_perm_b32 v196, v164, v160, s9
    v_perm_b32 v197, v172, v168, s9
    v_perm_b32 v198, v180, v176, s9
    v_perm_b32 v199, v188, v184, s9
    v_perm_b32 v200, v165, v161, s8
    v_perm_b32 v201, v173, v169, s8
    v_perm_b32 v202, v181, v177, s8
    v_perm_b32 v203, v189, v185, s8
    v_perm_b32 v204, v165, v161, s9
    v_perm_b32 v205, v173, v169, s9
    v_perm_b32 v206, v181, v177, s9
    v_perm_b32 v207, v189, v185, s9
    v_perm_b32 v208, v166, v162, s8
    v_perm_b32 v209, v174, v170, s8
    v_perm_b32 v210, v182, v178, s8
    v_perm_b32 v211, v190, v186, s8
    v_perm_b32 v212, v166, v162, s9
    v_perm_b32 v213, v174, v170, s9
    v_perm_b32 v214, v182, v178, s9
    v_perm_b32 v215, v190, v186, s9
    v_perm_b32 v216, v167, v163, s8
    v_perm_b32 v217, v175, v171, s8
    v_perm_b32 v218, v183, v179, s8
    v_perm_b32 v219, v191, v187, s8
    v_perm_b32 v220, v167, v163, s9
    v_perm_b32 v221, v175, v171, s9
    v_perm_b32 v222, v183, v179, s9
    v_perm_b32 v223, v191, v187, s9
    v_mfma_f32_16x16x32_bf16 v[32:35], v[236:239], v[192:195], v[32:35]
    v_mfma_f32_16x16x32_bf16 v[36:39], v[236:239], v[196:199], v[36:39]
    v_mfma_f32_16x16x32_bf16 v[40:43], v[236:239], v[200:203], v[40:43]
    v_mfma_f32_16x16x32_bf16 v[44:47], v[236:239], v[204:207], v[44:47]
    v_mfma_f32_16x16x32_bf16 v[48:51], v[236:239], v[208:211], v[48:51]
    v_mfma_f32_16x16x32_bf16 v[52:55], v[236:239], v[212:215], v[52:55]
    v_mfma_f32_16x16x32_bf16 v[56:59], v[236:239], v[216:219], v[56:59]
    v_mfma_f32_16x16x32_bf16 v[60:63], v[236:239], v[220:223], v[60:63]
    s_waitcnt lgkmcnt(0)
    s_mul_i32 s4, s4, 0x9E3779B1
    s_add_u32 s4, s4, 0x7F4A7C15
    v_mov_b32 v241, s4
    v_mov_b32 v243, s4
    v_mov_b32 v245, s4
    v_mov_b32 v247, s4
    v_cndmask_b32 v10, v32, v40, s[12:13]
    v_cndmask_b32 v11, v48, v56, s[12:13]
    v_cndmask_b32 v240, v10, v11, s[14:15]
    v_cndmask_b32 v10, v36, v44, s[12:13]
    v_cndmask_b32 v11, v52, v60, s[12:13]
    v_cndmask_b32 v242, v10, v11, s[14:15]
    buffer_store_dwordx4 v[240:243], v9, s[44:47], s76 offen offset:0 sc1
    v_cndmask_b32 v10, v33, v41, s[12:13]
    v_cndmask_b32 v11, v49, v57, s[12:13]
    v_cndmask_b32 v244, v10, v11, s[14:15]
    v_cndmask_b32 v10, v37, v45, s[12:13]
    v_cndmask_b32 v11, v53, v61, s[12:13]
    v_cndmask_b32 v246, v10, v11, s[14:15]
    buffer_store_dwordx4 v[244:247], v9, s[44:47], s76 offen offset:1024 sc1
    s_barrier
L_A_fetch:
    s_and_b32 s5, s79, 7
    s_lshl_b32 s5, s5, 1
    s_add_u32 s5, s5, s3
    s_lshl_b32 s5, s5, 14
    s_lshr_b32 s6, s79, 3
    s_lshl_b32 s6, s6, 10
    s_add_u32 s5, s5, s6
    s_add_u32 s5, s5, 524288
    v_lshlrev_b32 v7, 4, v0
    v_lshlrev_b32 v9, 6, v2
    v_lshl_add_u32 v9, v1, 2, v9
    s_lshl_b32 s6, s3, 5
    v_add_u32 v9, s6, v9
    s_mov_b32 s11, 20000
    s_add_u32 s80, s42, s5
    s_addc_u32 s81, s43, 0
L_A_sp:
    s_load_dword s48, s[80:81], 1020 glc
    s_load_dword s49, s[80:81], 3068 glc
    s_load_dword s50, s[80:81], 5116 glc
    s_load_dword s51, s[80:81], 7164 glc
    s_load_dword s52, s[80:81], 9212 glc
    s_load_dword s53, s[80:81], 11260 glc
    s_load_dword s54, s[80:81], 13308 glc
    s_load_dword s55, s[80:81], 15356 glc
    s_waitcnt lgkmcnt(0)
    s_xor_b32 s48, s48, s4
    s_xor_b32 s49, s49, s4
    s_or_b32 s48, s48, s49
    s_xor_b32 s50, s50, s4
    s_or_b32 s48, s48, s50
    s_xor_b32 s51, s51, s4
    s_or_b32 s48, s48, s51
    s_xor_b32 s52, s52, s4
    s_or_b32 s48, s48, s52
    s_xor_b32 s53, s53, s4
    s_or_b32 s48, s48, s53
    s_xor_b32 s54, s54, s4
    s_or_b32 s48, s48, s54
    s_xor_b32 s55, s55, s4
    s_or_b32 s48, s48, s55
    s_cbranch_scc0 L_A_pq2
    s_sleep 8
    s_sub_u32 s11, s11, 1
    s_cmp_gt_i32 s11, 0
    s_cbranch_scc1 L_A_sp
L_A_pq2:
    s_mov_b32 s6, s5
    buffer_load_dwordx4 v[64:67], v7, s[44:47], s6 offen offset:0 sc1
    buffer_load_dwordx4 v[68:71], v7, s[44:47], s6 offen offset:2048 sc1
    s_add_u32 s6, s6, 4096
    buffer_load_dwordx4 v[72:75], v7, s[44:47], s6 offen offset:0 sc1
    buffer_load_dwordx4 v[76:79], v7, s[44:47], s6 offen offset:2048 sc1
    s_add_u32 s6, s6, 4096
    buffer_load_dwordx4 v[80:83], v7, s[44:47], s6 offen offset:0 sc1
    buffer_load_dwordx4 v[84:87], v7, s[44:47], s6 offen offset:2048 sc1
    s_add_u32 s6, s6, 4096
    buffer_load_dwordx4 v[88:91], v7, s[44:47], s6 offen offset:0 sc1
    buffer_load_dwordx4 v[92:95], v7, s[44:47], s6 offen offset:2048 sc1
    s_waitcnt vmcnt(0)
    v_xor_b32 v10, s4, v65
    v_bitop3_b32 v10, v10, v67, s4 bitop3:0xf6
    v_bitop3_b32 v10, v10, v69, s4 bitop3:0xf6
    v_bitop3_b32 v10, v10, v71, s4 bitop3:0xf6
    v_bitop3_b32 v10, v10, v73, s4 bitop3:0xf6
    v_bitop3_b32 v10, v10, v75, s4 bitop3:0xf6
    v_bitop3_b32 v10, v10, v77, s4 bitop3:0xf6
    v_bitop3_b32 v10, v10, v79, s4 bitop3:0xf6
    v_bitop3_b32 v10, v10, v81, s4 bitop3:0xf6
    v_bitop3_b32 v10, v10, v83, s4 bitop3:0xf6
    v_bitop3_b32 v10, v10, v85, s4 bitop3:0xf6
    v_bitop3_b32 v10, v10, v87, s4 bitop3:0xf6
    v_bitop3_b32 v10, v10, v89, s4 bitop3:0xf6
    v_bitop3_b32 v10, v10, v91, s4 bitop3:0xf6
    v_bitop3_b32 v10, v10, v93, s4 bitop3:0xf6
    v_bitop3_b32 v10, v10, v95, s4 bitop3:0xf6
    v_cmp_ne_u32 vcc, 0, v10
    s_cbranch_vccz L_A_pqd
    s_sleep 2
    s_sub_u32 s11, s11, 1
    s_cmp_gt_i32 s11, 0
    s_cbranch_scc1 L_A_pq2
L_A_pqd:
    v_add_f32 v64, v64, v68
    v_add_f32 v72, v72, v76
    v_add_f32 v66, v66, v70
    v_add_f32 v74, v74, v78
    v_add_f32 v64, v64, v72
    v_add_f32 v66, v66, v74
    v_cvt_pk_bf16_f32 v65, v64, v66
    ds_write_b32 v9, v65 offset:256
    v_add_f32 v80, v80, v84
    v_add_f32 v88, v88, v92
    v_add_f32 v82, v82, v86
    v_add_f32 v90, v90, v94
    v_add_f32 v80, v80, v88
    v_add_f32 v82, v82, v90
    v_cvt_pk_bf16_f32 v81, v80, v82
    ds_write_b32 v9, v81 offset:272
    v_mov_b32 v9, 1
    s_waitcnt lgkmcnt(0)
    s_mov_b64 exec, 1
    ds_add_u32 v8, v9
    s_mov_b64 exec, -1
L_A_waitq:
    v_lshlrev_b32 v24, 9, v2
    v_lshl_add_u32 v24, v1, 7, v24
    s_lshl_b32 s5, s3, 11
    v_add_u32 v24, s5, v24
    v_lshlrev_b32 v25, 5, v2
    s_lshl_b32 s5, s3, 2
    v_add_u32 v25, s5, v25
    s_and_b32 s5, s3, 3
    v_and_b32 v9, 31, v0
    v_lshlrev_b32 v26, 4, v9
    s_lshl_b32 s6, s5, 9
    v_add_u32 v26, s6, v26
    s_lshl_b32 s6, s5, 5
    v_mov_b32 v27, s6
    s_and_b32 s6, s79, 7
    s_lshl_b32 s6, s6, 2
    s_add_u32 s5, s5, s6
    s_mul_i32 s5, s5, 10240
    s_add_u32 s77, s5, 131072
    s_lshl_b32 s6, s70, 1
    s_lshr_b32 s7, s79, 3
    s_add_u32 s6, s6, s7
    s_lshl_b32 s6, s6, 8
    s_add_u32 s77, s77, s6
    v_and_b32 v9, 1, v1
    v_mul_u32_u24 v28, 5120, v9
    v_lshl_add_u32 v28, v2, 4, v28
    s_mov_b32 s82, 0x000f000f
    s_mov_b32 s83, 0x000f000f
    s_lshl_b32 s5, s79, 8
    s_add_u32 s5, s5, 4096
    s_add_u32 s98, s42, s5
    s_addc_u32 s99, s43, 0
    s_cmp_lt_u32 s2, 128
    s_cselect_b32 s5, 4, 4
    s_add_u32 s6, s3, 6
    s_and_b32 s6, s6, 7
    s_cmp_lt_u32 s6, s5
    s_cselect_b32 s100, 1, 0
    v_mov_b32 v5, 0xff800000
    v_mov_b32 v6, 0
    v_mov_b32 v32, 0
    v_mov_b32 v33, 0
    v_mov_b32 v34, 0
    v_mov_b32 v35, 0
    v_mov_b32 v36, 0
    v_mov_b32 v37, 0
    v_mov_b32 v38, 0
    v_mov_b32 v39, 0
    v_mov_b32 v40, 0
    v_mov_b32 v41, 0
    v_mov_b32 v42, 0
    v_mov_b32 v43, 0
    v_mov_b32 v44, 0
    v_mov_b32 v45, 0
    v_mov_b32 v46, 0
    v_mov_b32 v47, 0
    v_mov_b32 v48, 0
    v_mov_b32 v49, 0
    v_mov_b32 v50, 0
    v_mov_b32 v51, 0
    v_mov_b32 v52, 0
    v_mov_b32 v53, 0
    v_mov_b32 v54, 0
    v_mov_b32 v55, 0
    v_mov_b32 v56, 0
    v_mov_b32 v57, 0
    v_mov_b32 v58, 0
    v_mov_b32 v59, 0
    v_mov_b32 v60, 0
    v_mov_b32 v61, 0
    v_mov_b32 v62, 0
    v_mov_b32 v63, 0
    v_and_b32 v7, 3, v2
    v_lshlrev_b32 v7, 4, v7
    v_lshl_add_u32 v7, v1, 7, v7
    v_bfe_u32 v9, v2, 2, 1
    v_lshl_add_u32 v7, v9, 6, v7
    s_mov_b32 s11, 160000
L_A_lw:
    ds_read_b32 v9, v8
    s_waitcnt lgkmcnt(0)
    v_cmp_ne_u32 vcc, 2, v9
    s_cbranch_vccz L_A_lwd
    s_sleep 1
    s_sub_u32 s11, s11, 1
    s_cmp_gt_i32 s11, 0
    s_cbranch_scc1 L_A_lw
L_A_lwd:
    s_setprio 3
    s_mov_b32 s80, 0
    ds_read_b128 v[16:19], v7 offset:256
    ds_read_b128 v[20:23], v7 offset:768
    s_cmp_ge_u32 s2, 256
    s_cselect_b32 s5, 0, s3
    s_cmp_ge_u32 s5, 2
    s_cbranch_scc1 L_A_have0
    buffer_load_dwordx4 v[64:67], v3, s[56:59], s72 offen offset:0 nt
    buffer_load_dwordx4 v[68:71], v3, s[56:59], s72 offen offset:128 nt
    buffer_load_dwordx4 v[72:75], v3, s[56:59], s72 offen offset:512 nt
    buffer_load_dwordx4 v[76:79], v3, s[56:59], s72 offen offset:640 nt
    buffer_load_dwordx4 v[80:83], v3, s[56:59], s72 offen offset:1024 nt
    buffer_load_dwordx4 v[84:87], v3, s[56:59], s72 offen offset:1152 nt
    buffer_load_dwordx4 v[88:91], v3, s[56:59], s72 offen offset:1536 nt
    buffer_load_dwordx4 v[92:95], v3, s[56:59], s72 offen offset:1664 nt
    buffer_load_dwordx4 v[96:99], v4, s[60:63], s72 offen offset:0 nt
    buffer_load_dwordx4 v[100:103], v4, s[60:63], s72 offen offset:256 nt
    buffer_load_dwordx4 v[104:107], v4, s[60:63], s72 offen offset:512 nt
    buffer_load_dwordx4 v[108:111], v4, s[60:63], s72 offen offset:768 nt
    buffer_load_dwordx4 v[112:115], v4, s[60:63], s72 offen offset:1024 nt
    buffer_load_dwordx4 v[116:119], v4, s[60:63], s72 offen offset:1280 nt
    buffer_load_dwordx4 v[120:123], v4, s[60:63], s72 offen offset:1536 nt
    buffer_load_dwordx4 v[124:127], v4, s[60:63], s72 offen offset:1792 nt
    buffer_load_dwordx4 v[128:131], v3, s[56:59], s73 offen offset:0 nt
    buffer_load_dwordx4 v[132:135], v3, s[56:59], s73 offen offset:128 nt
    buffer_load_dwordx4 v[136:139], v3, s[56:59], s73 offen offset:512 nt
    buffer_load_dwordx4 v[140:143], v3, s[56:59], s73 offen offset:640 nt
    buffer_load_dwordx4 v[144:147], v3, s[56:59], s73 offen offset:1024 nt
    buffer_load_dwordx4 v[148:151], v3, s[56:59], s73 offen offset:1152 nt
    buffer_load_dwordx4 v[152:155], v3, s[56:59], s73 offen offset:1536 nt
    buffer_load_dwordx4 v[156:159], v3, s[56:59], s73 offen offset:1664 nt
    buffer_load_dwordx4 v[160:163], v4, s[60:63], s73 offen offset:0 nt
    buffer_load_dwordx4 v[164:167], v4, s[60:63], s73 offen offset:256 nt
    buffer_load_dwordx4 v[168:171], v4, s[60:63], s73 offen offset:512 nt
    buffer_load_dwordx4 v[172:175], v4, s[60:63], s73 offen offset:768 nt
    buffer_load_dwordx4 v[176:179], v4, s[60:63], s73 offen offset:1024 nt
    buffer_load_dwordx4 v[180:183], v4, s[60:63], s73 offen offset:1280 nt
    buffer_load_dwordx4 v[184:187], v4, s[60:63], s73 offen offset:1536 nt
    buffer_load_dwordx4 v[188:191], v4, s[60:63], s73 offen offset:1792 nt
L_A_have0:
    s_waitcnt lgkmcnt(0)
L_A_loop:
    s_mov_b32 s78, 96
    s_cmp_lt_u32 s73, 268435456
    s_cbranch_scc1 L_A_k24_0
    s_waitcnt vmcnt(8)
    s_branch L_A_kw_0
L_A_k24_0:
    s_waitcnt vmcnt(24)
    s_cmp_eq_u32 s100, 0
    s_cbranch_scc1 L_A_kn_0
    s_mov_b32 s78, 1
    s_atomic_add s78, s[98:99], 0 glc
L_A_kn_0:
    s_waitcnt vmcnt(24)
L_A_kw_0:
    v_mfma_f32_16x16x32_bf16 v[236:239], v[64:67], v[16:19], 0
    v_mfma_f32_16x16x32_bf16 v[240:243], v[72:75], v[16:19], 0
    v_mfma_f32_16x16x32_bf16 v[244:247], v[80:83], v[16:19], 0
    v_mfma_f32_16x16x32_bf16 v[248:251], v[88:91], v[16:19], 0
    v_mfma_f32_16x16x32_bf16 v[236:239], v[68:71], v[20:23], v[236:239]
    v_mfma_f32_16x16x32_bf16 v[240:243], v[76:79], v[20:23], v[240:243]
    v_mfma_f32_16x16x32_bf16 v[244:247], v[84:87], v[20:23], v[244:247]
    v_mfma_f32_16x16x32_bf16 v[248:251], v[92:95], v[20:23], v[248:251]
    s_nop 3
    s_nop 0
    v_add_f32_dpp v224, v237, v236 row_ror:4 row_mask:0xf bank_mask:0xf
    v_add_f32_dpp v225, v239, v238 row_ror:4 row_mask:0xf bank_mask:0xf
    v_add_f32_dpp v226, v241, v240 row_ror:4 row_mask:0xf bank_mask:0xf
    v_add_f32_dpp v227, v243, v242 row_ror:4 row_mask:0xf bank_mask:0xf
    v_add_f32_dpp v228, v245, v244 row_ror:4 row_mask:0xf bank_mask:0xf
    v_add_f32_dpp v229, v247, v246 row_ror:4 row_mask:0xf bank_mask:0xf
    v_add_f32_dpp v230, v249, v248 row_ror:4 row_mask:0xf bank_mask:0xf
    v_add_f32_dpp v231, v251, v250 row_ror:4 row_mask:0xf bank_mask:0xf
    v_max3_f32 v7, v224, v225, v226
    v_max3_f32 v8, v227, v228, v229
    v_max3_f32 v7, v7, v230, v231
    v_max3_f32 v7, v7, v8, v5
    v_mov_b32 v8, v7
    s_nop 1
    v_permlane16_swap_b32 v7, v8
    v_max_f32 v7, v7, v8
    v_mov_b32 v8, v7
    s_nop 1
    v_permlane32_swap_b32 v7, v8
    v_max_f32 v7, v7, v8
    v_sub_f32 v9, v5, v7
    v_mul_f32 v9, s10, v9
    v_exp_f32 v10, v9
    v_mov_b32 v5, v7
    v_mul_f32 v8, s10, v7
    v_fma_f32 v224, v224, s10, -v8
    v_fma_f32 v225, v225, s10, -v8
    v_fma_f32 v226, v226, s10, -v8
    v_fma_f32 v227, v227, s10, -v8
    v_fma_f32 v228, v228, s10, -v8
    v_fma_f32 v229, v229, s10, -v8
    v_fma_f32 v230, v230, s10, -v8
    v_fma_f32 v231, v231, s10, -v8
    v_exp_f32 v224, v224
    v_exp_f32 v225, v225
    v_exp_f32 v226, v226
    v_exp_f32 v227, v227
    v_exp_f32 v228, v228
    v_exp_f32 v229, v229
    v_exp_f32 v230, v230
    v_exp_f32 v231, v231
    v_mov_b32 v11, v10
    v_pk_mul_f32 v[32:33], v[32:33], v[10:11]
    v_pk_mul_f32 v[34:35], v[34:35], v[10:11]
    v_pk_mul_f32 v[36:37], v[36:37], v[10:11]
    v_pk_mul_f32 v[38:39], v[38:39], v[10:11]
    v_pk_mul_f32 v[40:41], v[40:41], v[10:11]
    v_pk_mul_f32 v[42:43], v[42:43], v[10:11]
    v_pk_mul_f32 v[44:45], v[44:45], v[10:11]
    v_pk_mul_f32 v[46:47], v[46:47], v[10:11]
    v_pk_mul_f32 v[48:49], v[48:49], v[10:11]
    v_pk_mul_f32 v[50:51], v[50:51], v[10:11]
    v_pk_mul_f32 v[52:53], v[52:53], v[10:11]
    v_pk_mul_f32 v[54:55], v[54:55], v[10:11]
    v_pk_mul_f32 v[56:57], v[56:57], v[10:11]
    v_pk_mul_f32 v[58:59], v[58:59], v[10:11]
    v_pk_mul_f32 v[60:61], v[60:61], v[10:11]
    v_pk_mul_f32 v[62:63], v[62:63], v[10:11]
    v_cvt_pk_bf16_f32 v232, v224, v225
    v_cvt_pk_bf16_f32 v233, v226, v227
    v_cvt_pk_bf16_f32 v234, v228, v229
    v_cvt_pk_bf16_f32 v235, v230, v231
    v_add_f32 v12, v224, v225
    v_add_f32 v13, v226, v227
    v_add_f32 v14, v228, v229
    v_add_f32 v15, v230, v231
    v_add_f32 v12, v12, v13
    v_add_f32 v14, v14, v15
    v_add_f32 v12, v12, v14
    v_fma_f32 v6, v6, v10, v12
    s_waitcnt lgkmcnt(0)
    s_cmp_lg_u32 s78, 101
    s_cbranch_scc1 L_A_nx_0
    s_mov_b32 s101, s4
    s_atomic_add s101, s[98:99], 128 glc
L_A_nx_0:
    s_cmp_lt_u32 s78, 72
    s_cselect_b32 s100, s100, 0
    s_lshl_b32 s75, s78, 13
    s_add_u32 s75, s75, s74
    s_cmp_lt_u32 s78, 96
    s_cselect_b32 s72, s75, 268435456
    s_cbranch_scc0 L_A_nk_0
    buffer_load_dwordx4 v[64:67], v3, s[56:59], s72 offen offset:0 nt
    buffer_load_dwordx4 v[68:71], v3, s[56:59], s72 offen offset:128 nt
    buffer_load_dwordx4 v[72:75], v3, s[56:59], s72 offen offset:512 nt
    buffer_load_dwordx4 v[76:79], v3, s[56:59], s72 offen offset:640 nt
    buffer_load_dwordx4 v[80:83], v3, s[56:59], s72 offen offset:1024 nt
    buffer_load_dwordx4 v[84:87], v3, s[56:59], s72 offen offset:1152 nt
    buffer_load_dwordx4 v[88:91], v3, s[56:59], s72 offen offset:1536 nt
    buffer_load_dwordx4 v[92:95], v3, s[56:59], s72 offen offset:1664 nt
L_A_nk_0:
    s_cmp_lt_u32 s72, 268435456
    s_cbranch_scc1 L_A_v24_0
    s_cmp_lt_u32 s73, 268435456
    s_cbranch_scc1 L_A_v16_0
    s_waitcnt vmcnt(0)
L_A_v16_0:
    s_waitcnt vmcnt(16)
L_A_v24_0:
    s_waitcnt vmcnt(24)
    v_perm_b32 v192, v100, v96, s8
    v_perm_b32 v193, v108, v104, s8
    v_perm_b32 v194, v116, v112, s8
    v_perm_b32 v195, v124, v120, s8
    v_perm_b32 v196, v100, v96, s9
    v_perm_b32 v197, v108, v104, s9
    v_perm_b32 v198, v116, v112, s9
    v_perm_b32 v199, v124, v120, s9
    v_perm_b32 v200, v101, v97, s8
    v_perm_b32 v201, v109, v105, s8
    v_perm_b32 v202, v117, v113, s8
    v_perm_b32 v203, v125, v121, s8
    v_perm_b32 v204, v101, v97, s9
    v_perm_b32 v205, v109, v105, s9
    v_perm_b32 v206, v117, v113, s9
    v_perm_b32 v207, v125, v121, s9
    v_perm_b32 v208, v102, v98, s8
    v_perm_b32 v209, v110, v106, s8
    v_perm_b32 v210, v118, v114, s8
    v_perm_b32 v211, v126, v122, s8
    v_perm_b32 v212, v102, v98, s9
    v_perm_b32 v213, v110, v106, s9
    v_perm_b32 v214, v118, v114, s9
    v_perm_b32 v215, v126, v122, s9
    v_perm_b32 v216, v103, v99, s8
    v_perm_b32 v217, v111, v107, s8
    v_perm_b32 v218, v119, v115, s8
    v_perm_b32 v219, v127, v123, s8
    v_perm_b32 v220, v103, v99, s9
    v_perm_b32 v221, v111, v107, s9
    v_perm_b32 v222, v119, v115, s9
    v_perm_b32 v223, v127, v123, s9
    v_mfma_f32_16x16x32_bf16 v[32:35], v[192:195], v[232:235], v[32:35]
    v_mfma_f32_16x16x32_bf16 v[36:39], v[196:199], v[232:235], v[36:39]
    v_mfma_f32_16x16x32_bf16 v[40:43], v[200:203], v[232:235], v[40:43]
    v_mfma_f32_16x16x32_bf16 v[44:47], v[204:207], v[232:235], v[44:47]
    v_mfma_f32_16x16x32_bf16 v[48:51], v[208:211], v[232:235], v[48:51]
    v_mfma_f32_16x16x32_bf16 v[52:55], v[212:215], v[232:235], v[52:55]
    v_mfma_f32_16x16x32_bf16 v[56:59], v[216:219], v[232:235], v[56:59]
    v_mfma_f32_16x16x32_bf16 v[60:63], v[220:223], v[232:235], v[60:63]
    s_cmp_lt_u32 s72, 268435456
    s_cbranch_scc0 L_A_nv_0
    buffer_load_dwordx4 v[96:99], v4, s[60:63], s72 offen offset:0 nt
    buffer_load_dwordx4 v[100:103], v4, s[60:63], s72 offen offset:256 nt
    buffer_load_dwordx4 v[104:107], v4, s[60:63], s72 offen offset:512 nt
    buffer_load_dwordx4 v[108:111], v4, s[60:63], s72 offen offset:768 nt
    buffer_load_dwordx4 v[112:115], v4, s[60:63], s72 offen offset:1024 nt
    buffer_load_dwordx4 v[116:119], v4, s[60:63], s72 offen offset:1280 nt
    buffer_load_dwordx4 v[120:123], v4, s[60:63], s72 offen offset:1536 nt
    buffer_load_dwordx4 v[124:127], v4, s[60:63], s72 offen offset:1792 nt
L_A_nv_0:
    s_setprio 2
    s_mov_b32 s78, 96
    s_cmp_lt_u32 s72, 268435456
    s_cbranch_scc1 L_A_k24_1
    s_waitcnt vmcnt(8)
    s_branch L_A_kw_1
L_A_k24_1:
    s_waitcnt vmcnt(24)
    s_waitcnt vmcnt(24)
L_A_kw_1:
    v_mfma_f32_16x16x32_bf16 v[236:239], v[128:131], v[16:19], 0
    v_mfma_f32_16x16x32_bf16 v[240:243], v[136:139], v[16:19], 0
    v_mfma_f32_16x16x32_bf16 v[244:247], v[144:147], v[16:19], 0
    v_mfma_f32_16x16x32_bf16 v[248:251], v[152:155], v[16:19], 0
    v_mfma_f32_16x16x32_bf16 v[236:239], v[132:135], v[20:23], v[236:239]
    v_mfma_f32_16x16x32_bf16 v[240:243], v[140:143], v[20:23], v[240:243]
    v_mfma_f32_16x16x32_bf16 v[244:247], v[148:151], v[20:23], v[244:247]
    v_mfma_f32_16x16x32_bf16 v[248:251], v[156:159], v[20:23], v[248:251]
    s_nop 3
    s_nop 0
    v_add_f32_dpp v224, v237, v236 row_ror:4 row_mask:0xf bank_mask:0xf
    v_add_f32_dpp v225, v239, v238 row_ror:4 row_mask:0xf bank_mask:0xf
    v_add_f32_dpp v226, v241, v240 row_ror:4 row_mask:0xf bank_mask:0xf
    v_add_f32_dpp v227, v243, v242 row_ror:4 row_mask:0xf bank_mask:0xf
    v_add_f32_dpp v228, v245, v244 row_ror:4 row_mask:0xf bank_mask:0xf
    v_add_f32_dpp v229, v247, v246 row_ror:4 row_mask:0xf bank_mask:0xf
    v_add_f32_dpp v230, v249, v248 row_ror:4 row_mask:0xf bank_mask:0xf
    v_add_f32_dpp v231, v251, v250 row_ror:4 row_mask:0xf bank_mask:0xf
    v_max3_f32 v7, v224, v225, v226
    v_max3_f32 v8, v227, v228, v229
    v_max3_f32 v7, v7, v230, v231
    v_max3_f32 v7, v7, v8, v5
    v_mov_b32 v8, v7
    s_nop 1
    v_permlane16_swap_b32 v7, v8
    v_max_f32 v7, v7, v8
    v_mov_b32 v8, v7
    s_nop 1
    v_permlane32_swap_b32 v7, v8
    v_max_f32 v7, v7, v8
    v_sub_f32 v9, v5, v7
    v_mul_f32 v9, s10, v9
    v_exp_f32 v10, v9
    v_mov_b32 v5, v7
    v_mul_f32 v8, s10, v7
    v_fma_f32 v224, v224, s10, -v8
    v_fma_f32 v225, v225, s10, -v8
    v_fma_f32 v226, v226, s10, -v8
    v_fma_f32 v227, v227, s10, -v8
    v_fma_f32 v228, v228, s10, -v8
    v_fma_f32 v229, v229, s10, -v8
    v_fma_f32 v230, v230, s10, -v8
    v_fma_f32 v231, v231, s10, -v8
    v_exp_f32 v224, v224
    v_exp_f32 v225, v225
    v_exp_f32 v226, v226
    v_exp_f32 v227, v227
    v_exp_f32 v228, v228
    v_exp_f32 v229, v229
    v_exp_f32 v230, v230
    v_exp_f32 v231, v231
    v_mov_b32 v11, v10
    v_pk_mul_f32 v[32:33], v[32:33], v[10:11]
    v_pk_mul_f32 v[34:35], v[34:35], v[10:11]
    v_pk_mul_f32 v[36:37], v[36:37], v[10:11]
    v_pk_mul_f32 v[38:39], v[38:39], v[10:11]
    v_pk_mul_f32 v[40:41], v[40:41], v[10:11]
    v_pk_mul_f32 v[42:43], v[42:43], v[10:11]
    v_pk_mul_f32 v[44:45], v[44:45], v[10:11]
    v_pk_mul_f32 v[46:47], v[46:47], v[10:11]
    v_pk_mul_f32 v[48:49], v[48:49], v[10:11]
    v_pk_mul_f32 v[50:51], v[50:51], v[10:11]
    v_pk_mul_f32 v[52:53], v[52:53], v[10:11]
    v_pk_mul_f32 v[54:55], v[54:55], v[10:11]
    v_pk_mul_f32 v[56:57], v[56:57], v[10:11]
    v_pk_mul_f32 v[58:59], v[58:59], v[10:11]
    v_pk_mul_f32 v[60:61], v[60:61], v[10:11]
    v_pk_mul_f32 v[62:63], v[62:63], v[10:11]
    v_cvt_pk_bf16_f32 v232, v224, v225
    v_cvt_pk_bf16_f32 v233, v226, v227
    v_cvt_pk_bf16_f32 v234, v228, v229
    v_cvt_pk_bf16_f32 v235, v230, v231
    v_add_f32 v12, v224, v225
    v_add_f32 v13, v226, v227
    v_add_f32 v14, v228, v229
    v_add_f32 v15, v230, v231
    v_add_f32 v12, v12, v13
    v_add_f32 v14, v14, v15
    v_add_f32 v12, v12, v14
    v_fma_f32 v6, v6, v10, v12
    s_waitcnt lgkmcnt(0)
    s_lshl_b32 s75, s78, 13
    s_add_u32 s75, s75, s74
    s_cmp_lt_u32 s78, 96
    s_cselect_b32 s73, s75, 268435456
    s_cbranch_scc0 L_A_nk_1
    buffer_load_dwordx4 v[128:131], v3, s[56:59], s73 offen offset:0 nt
    buffer_load_dwordx4 v[132:135], v3, s[56:59], s73 offen offset:128 nt
    buffer_load_dwordx4 v[136:139], v3, s[56:59], s73 offen offset:512 nt
    buffer_load_dwordx4 v[140:143], v3, s[56:59], s73 offen offset:640 nt
    buffer_load_dwordx4 v[144:147], v3, s[56:59], s73 offen offset:1024 nt
    buffer_load_dwordx4 v[148:151], v3, s[56:59], s73 offen offset:1152 nt
    buffer_load_dwordx4 v[152:155], v3, s[56:59], s73 offen offset:1536 nt
    buffer_load_dwordx4 v[156:159], v3, s[56:59], s73 offen offset:1664 nt
L_A_nk_1:
    s_cmp_lt_u32 s73, 268435456
    s_cbranch_scc1 L_A_v24_1
    s_cmp_lt_u32 s72, 268435456
    s_cbranch_scc1 L_A_v16_1
    s_waitcnt vmcnt(0)
L_A_v16_1:
    s_waitcnt vmcnt(16)
L_A_v24_1:
    s_waitcnt vmcnt(24)
    v_perm_b32 v192, v164, v160, s8
    v_perm_b32 v193, v172, v168, s8
    v_perm_b32 v194, v180, v176, s8
    v_perm_b32 v195, v188, v184, s8
    v_perm_b32 v196, v164, v160, s9
    v_perm_b32 v197, v172, v168, s9
    v_perm_b32 v198, v180, v176, s9
    v_perm_b32 v199, v188, v184, s9
    v_perm_b32 v200, v165, v161, s8
    v_perm_b32 v201, v173, v169, s8
    v_perm_b32 v202, v181, v177, s8
    v_perm_b32 v203, v189, v185, s8
    v_perm_b32 v204, v165, v161, s9
    v_perm_b32 v205, v173, v169, s9
    v_perm_b32 v206, v181, v177, s9
    v_perm_b32 v207, v189, v185, s9
    v_perm_b32 v208, v166, v162, s8
    v_perm_b32 v209, v174, v170, s8
    v_perm_b32 v210, v182, v178, s8
    v_perm_b32 v211, v190, v186, s8
    v_perm_b32 v212, v166, v162, s9
    v_perm_b32 v213, v174, v170, s9
    v_perm_b32 v214, v182, v178, s9
    v_perm_b32 v215, v190, v186, s9
    v_perm_b32 v216, v167, v163, s8
    v_perm_b32 v217, v175, v171, s8
    v_perm_b32 v218, v183, v179, s8
    v_perm_b32 v219, v191, v187, s8
    v_perm_b32 v220, v167, v163, s9
    v_perm_b32 v221, v175, v171, s9
    v_perm_b32 v222, v183, v179, s9
    v_perm_b32 v223, v191, v187, s9
    v_mfma_f32_16x16x32_bf16 v[32:35], v[192:195], v[232:235], v[32:35]
    v_mfma_f32_16x16x32_bf16 v[36:39], v[196:199], v[232:235], v[36:39]
    v_mfma_f32_16x16x32_bf16 v[40:43], v[200:203], v[232:235], v[40:43]
    v_mfma_f32_16x16x32_bf16 v[44:47], v[204:207], v[232:235], v[44:47]
    v_mfma_f32_16x16x32_bf16 v[48:51], v[208:211], v[232:235], v[48:51]
    v_mfma_f32_16x16x32_bf16 v[52:55], v[212:215], v[232:235], v[52:55]
    v_mfma_f32_16x16x32_bf16 v[56:59], v[216:219], v[232:235], v[56:59]
    v_mfma_f32_16x16x32_bf16 v[60:63], v[220:223], v[232:235], v[60:63]
    s_cmp_lt_u32 s73, 268435456
    s_cbranch_scc0 L_A_nv_1
    buffer_load_dwordx4 v[160:163], v4, s[60:63], s73 offen offset:0 nt
    buffer_load_dwordx4 v[164:167], v4, s[60:63], s73 offen offset:256 nt
    buffer_load_dwordx4 v[168:171], v4, s[60:63], s73 offen offset:512 nt
    buffer_load_dwordx4 v[172:175], v4, s[60:63], s73 offen offset:768 nt
    buffer_load_dwordx4 v[176:179], v4, s[60:63], s73 offen offset:1024 nt
    buffer_load_dwordx4 v[180:183], v4, s[60:63], s73 offen offset:1280 nt
    buffer_load_dwordx4 v[184:187], v4, s[60:63], s73 offen offset:1536 nt
    buffer_load_dwordx4 v[188:191], v4, s[60:63], s73 offen offset:1792 nt
L_A_nv_1:
    s_setprio 1
    s_cmp_lt_u32 s72, 268435456
    s_cbranch_scc0 L_A_fin
L_A_sloop:
    s_mov_b32 s78, 96
    s_waitcnt vmcnt(8)
    s_cmp_eq_u32 s100, 0
    s_cbranch_scc1 L_A_kn_2
    s_mov_b32 s78, 1
    s_atomic_add s78, s[98:99], 0 glc
L_A_kn_2:
    v_mfma_f32_16x16x32_bf16 v[236:239], v[64:67], v[16:19], 0
    v_mfma_f32_16x16x32_bf16 v[240:243], v[72:75], v[16:19], 0
    v_mfma_f32_16x16x32_bf16 v[244:247], v[80:83], v[16:19], 0
    v_mfma_f32_16x16x32_bf16 v[248:251], v[88:91], v[16:19], 0
    v_mfma_f32_16x16x32_bf16 v[236:239], v[68:71], v[20:23], v[236:239]
    v_mfma_f32_16x16x32_bf16 v[240:243], v[76:79], v[20:23], v[240:243]
    v_mfma_f32_16x16x32_bf16 v[244:247], v[84:87], v[20:23], v[244:247]
    v_mfma_f32_16x16x32_bf16 v[248:251], v[92:95], v[20:23], v[248:251]
    s_nop 3
    s_nop 0
    v_add_f32_dpp v224, v237, v236 row_ror:4 row_mask:0xf bank_mask:0xf
    v_add_f32_dpp v225, v239, v238 row_ror:4 row_mask:0xf bank_mask:0xf
    v_add_f32_dpp v226, v241, v240 row_ror:4 row_mask:0xf bank_mask:0xf
    v_add_f32_dpp v227, v243, v242 row_ror:4 row_mask:0xf bank_mask:0xf
    v_add_f32_dpp v228, v245, v244 row_ror:4 row_mask:0xf bank_mask:0xf
    v_add_f32_dpp v229, v247, v246 row_ror:4 row_mask:0xf bank_mask:0xf
    v_add_f32_dpp v230, v249, v248 row_ror:4 row_mask:0xf bank_mask:0xf
    v_add_f32_dpp v231, v251, v250 row_ror:4 row_mask:0xf bank_mask:0xf
    v_max3_f32 v7, v224, v225, v226
    v_max3_f32 v8, v227, v228, v229
    v_max3_f32 v7, v7, v230, v231
    v_max3_f32 v7, v7, v8, v5
    v_mov_b32 v8, v7
    s_nop 1
    v_permlane16_swap_b32 v7, v8
    v_max_f32 v7, v7, v8
    v_mov_b32 v8, v7
    s_nop 1
    v_permlane32_swap_b32 v7, v8
    v_max_f32 v7, v7, v8
    v_sub_f32 v9, v5, v7
    v_mul_f32 v9, s10, v9
    v_exp_f32 v10, v9
    v_mov_b32 v5, v7
    v_mul_f32 v8, s10, v7
    v_fma_f32 v224, v224, s10, -v8
    v_fma_f32 v225, v225, s10, -v8
    v_fma_f32 v226, v226, s10, -v8
    v_fma_f32 v227, v227, s10, -v8
    v_fma_f32 v228, v228, s10, -v8
    v_fma_f32 v229, v229, s10, -v8
    v_fma_f32 v230, v230, s10, -v8
    v_fma_f32 v231, v231, s10, -v8
    v_exp_f32 v224, v224
    v_exp_f32 v225, v225
    v_exp_f32 v226, v226
    v_exp_f32 v227, v227
    v_exp_f32 v228, v228
    v_exp_f32 v229, v229
    v_exp_f32 v230, v230
    v_exp_f32 v231, v231
    v_mov_b32 v11, v10
    v_pk_mul_f32 v[32:33], v[32:33], v[10:11]
    v_pk_mul_f32 v[34:35], v[34:35], v[10:11]
    v_pk_mul_f32 v[36:37], v[36:37], v[10:11]
    v_pk_mul_f32 v[38:39], v[38:39], v[10:11]
    v_pk_mul_f32 v[40:41], v[40:41], v[10:11]
    v_pk_mul_f32 v[42:43], v[42:43], v[10:11]
    v_pk_mul_f32 v[44:45], v[44:45], v[10:11]
    v_pk_mul_f32 v[46:47], v[46:47], v[10:11]
    v_pk_mul_f32 v[48:49], v[48:49], v[10:11]
    v_pk_mul_f32 v[50:51], v[50:51], v[10:11]
    v_pk_mul_f32 v[52:53], v[52:53], v[10:11]
    v_pk_mul_f32 v[54:55], v[54:55], v[10:11]
    v_pk_mul_f32 v[56:57], v[56:57], v[10:11]
    v_pk_mul_f32 v[58:59], v[58:59], v[10:11]
    v_pk_mul_f32 v[60:61], v[60:61], v[10:11]
    v_pk_mul_f32 v[62:63], v[62:63], v[10:11]
    v_cvt_pk_bf16_f32 v232, v224, v225
    v_cvt_pk_bf16_f32 v233, v226, v227
    v_cvt_pk_bf16_f32 v234, v228, v229
    v_cvt_pk_bf16_f32 v235, v230, v231
    v_add_f32 v12, v224, v225
    v_add_f32 v13, v226, v227
    v_add_f32 v14, v228, v229
    v_add_f32 v15, v230, v231
    v_add_f32 v12, v12, v13
    v_add_f32 v14, v14, v15
    v_add_f32 v12, v12, v14
    v_fma_f32 v6, v6, v10, v12
    s_waitcnt lgkmcnt(0)
    s_cmp_lg_u32 s78, 101
    s_cbranch_scc1 L_A_nx_2
    s_mov_b32 s101, s4
    s_atomic_add s101, s[98:99], 128 glc
L_A_nx_2:
    s_cmp_lt_u32 s78, 72
    s_cselect_b32 s100, s100, 0
    s_lshl_b32 s75, s78, 13
    s_add_u32 s75, s75, s74
    s_cmp_lt_u32 s78, 96
    s_cselect_b32 s72, s75, 268435456
    s_cbranch_scc0 L_A_last
    buffer_load_dwordx4 v[64:67], v3, s[56:59], s72 offen offset:0 nt
    buffer_load_dwordx4 v[68:71], v3, s[56:59], s72 offen offset:128 nt
    buffer_load_dwordx4 v[72:75], v3, s[56:59], s72 offen offset:512 nt
    buffer_load_dwordx4 v[76:79], v3, s[56:59], s72 offen offset:640 nt
    buffer_load_dwordx4 v[80:83], v3, s[56:59], s72 offen offset:1024 nt
    buffer_load_dwordx4 v[84:87], v3, s[56:59], s72 offen offset:1152 nt
    buffer_load_dwordx4 v[88:91], v3, s[56:59], s72 offen offset:1536 nt
    buffer_load_dwordx4 v[92:95], v3, s[56:59], s72 offen offset:1664 nt
L_A_nk_2:
    s_waitcnt vmcnt(8)
    v_perm_b32 v192, v100, v96, s8
    v_perm_b32 v193, v108, v104, s8
    v_perm_b32 v194, v116, v112, s8
    v_perm_b32 v195, v124, v120, s8
    v_perm_b32 v196, v100, v96, s9
    v_perm_b32 v197, v108, v104, s9
    v_perm_b32 v198, v116, v112, s9
    v_perm_b32 v199, v124, v120, s9
    v_perm_b32 v200, v101, v97, s8
    v_perm_b32 v201, v109, v105, s8
    v_perm_b32 v202, v117, v113, s8
    v_perm_b32 v203, v125, v121, s8
    v_perm_b32 v204, v101, v97, s9
    v_perm_b32 v205, v109, v105, s9
    v_perm_b32 v206, v117, v113, s9
    v_perm_b32 v207, v125, v121, s9
    v_perm_b32 v208, v102, v98, s8
    v_perm_b32 v209, v110, v106, s8
    v_perm_b32 v210, v118, v114, s8
    v_perm_b32 v211, v126, v122, s8
    v_perm_b32 v212, v102, v98, s9
    v_perm_b32 v213, v110, v106, s9
    v_perm_b32 v214, v118, v114, s9
    v_perm_b32 v215, v126, v122, s9
    v_perm_b32 v216, v103, v99, s8
    v_perm_b32 v217, v111, v107, s8
    v_perm_b32 v218, v119, v115, s8
    v_perm_b32 v219, v127, v123, s8
    v_perm_b32 v220, v103, v99, s9
    v_perm_b32 v221, v111, v107, s9
    v_perm_b32 v222, v119, v115, s9
    v_perm_b32 v223, v127, v123, s9
    v_mfma_f32_16x16x32_bf16 v[32:35], v[192:195], v[232:235], v[32:35]
    v_mfma_f32_16x16x32_bf16 v[36:39], v[196:199], v[232:235], v[36:39]
    v_mfma_f32_16x16x32_bf16 v[40:43], v[200:203], v[232:235], v[40:43]
    v_mfma_f32_16x16x32_bf16 v[44:47], v[204:207], v[232:235], v[44:47]
    v_mfma_f32_16x16x32_bf16 v[48:51], v[208:211], v[232:235], v[48:51]
    v_mfma_f32_16x16x32_bf16 v[52:55], v[212:215], v[232:235], v[52:55]
    v_mfma_f32_16x16x32_bf16 v[56:59], v[216:219], v[232:235], v[56:59]
    v_mfma_f32_16x16x32_bf16 v[60:63], v[220:223], v[232:235], v[60:63]
    buffer_load_dwordx4 v[96:99], v4, s[60:63], s72 offen offset:0 nt
    buffer_load_dwordx4 v[100:103], v4, s[60:63], s72 offen offset:256 nt
    buffer_load_dwordx4 v[104:107], v4, s[60:63], s72 offen offset:512 nt
    buffer_load_dwordx4 v[108:111], v4, s[60:63], s72 offen offset:768 nt
    buffer_load_dwordx4 v[112:115], v4, s[60:63], s72 offen offset:1024 nt
    buffer_load_dwordx4 v[116:119], v4, s[60:63], s72 offen offset:1280 nt
    buffer_load_dwordx4 v[120:123], v4, s[60:63], s72 offen offset:1536 nt
    buffer_load_dwordx4 v[124:127], v4, s[60:63], s72 offen offset:1792 nt
L_A_nv_2:
    s_setprio 0
    s_branch L_A_sloop
L_A_last:
    v_mov_b32 v8, v6
    s_nop 1
    v_permlane16_swap_b32 v6, v8
    v_add_f32 v6, v6, v8
    v_mov_b32 v8, v6
    s_nop 1
    v_permlane32_swap_b32 v6, v8
    v_add_f32 v6, v6, v8
    v_mul_f32 v5, s10, v5
    s_mov_b64 exec, s[82:83]
    ds_write_b32 v25, v5 offset:4608
    ds_write_b32 v25, v6 offset:4736
    s_mov_b64 exec, -1
    s_waitcnt lgkmcnt(0)
    s_barrier
    s_waitcnt vmcnt(0)
    v_perm_b32 v192, v100, v96, s8
    v_perm_b32 v193, v108, v104, s8
    v_perm_b32 v194, v116, v112, s8
    v_perm_b32 v195, v124, v120, s8
    v_perm_b32 v196, v100, v96, s9
    v_perm_b32 v197, v108, v104, s9
    v_perm_b32 v198, v116, v112, s9
    v_perm_b32 v199, v124, v120, s9
    v_mfma_f32_16x16x32_bf16 v[32:35], v[192:195], v[232:235], v[32:35]
    v_perm_b32 v200, v101, v97, s8
    v_perm_b32 v201, v109, v105, s8
    v_perm_b32 v202, v117, v113, s8
    v_perm_b32 v203, v125, v121, s8
    v_mfma_f32_16x16x32_bf16 v[36:39], v[196:199], v[232:235], v[36:39]
    v_perm_b32 v204, v101, v97, s9
    v_perm_b32 v205, v109, v105, s9
    v_perm_b32 v206, v117, v113, s9
    v_perm_b32 v207, v125, v121, s9
    v_mfma_f32_16x16x32_bf16 v[40:43], v[200:203], v[232:235], v[40:43]
    s_mov_b64 exec, s[82:83]
    ds_write_b128 v24, v[32:35] offset:8192
    s_mov_b64 exec, -1
    v_perm_b32 v208, v102, v98, s8
    v_perm_b32 v209, v110, v106, s8
    v_perm_b32 v210, v118, v114, s8
    v_perm_b32 v211, v126, v122, s8
    v_mfma_f32_16x16x32_bf16 v[44:47], v[204:207], v[232:235], v[44:47]
    s_mov_b64 exec, s[82:83]
    ds_write_b128 v24, v[36:39] offset:8208
    s_mov_b64 exec, -1
    v_perm_b32 v212, v102, v98, s9
    v_perm_b32 v213, v110, v106, s9
    v_perm_b32 v214, v118, v114, s9
    v_perm_b32 v215, v126, v122, s9
    v_mfma_f32_16x16x32_bf16 v[48:51], v[208:211], v[232:235], v[48:51]
    s_mov_b64 exec, s[82:83]
    ds_write_b128 v24, v[40:43] offset:8224
    s_mov_b64 exec, -1
    v_perm_b32 v216, v103, v99, s8
    v_perm_b32 v217, v111, v107, s8
    v_perm_b32 v218, v119, v115, s8
    v_perm_b32 v219, v127, v123, s8
    v_mfma_f32_16x16x32_bf16 v[52:55], v[212:215], v[232:235], v[52:55]
    s_mov_b64 exec, s[82:83]
    ds_write_b128 v24, v[44:47] offset:8240
    s_mov_b64 exec, -1
    v_perm_b32 v220, v103, v99, s9
    v_perm_b32 v221, v111, v107, s9
    v_perm_b32 v222, v119, v115, s9
    v_perm_b32 v223, v127, v123, s9
    v_mfma_f32_16x16x32_bf16 v[56:59], v[216:219], v[232:235], v[56:59]
    s_mov_b64 exec, s[82:83]
    ds_write_b128 v24, v[48:51] offset:8256
    s_mov_b64 exec, -1
    v_mfma_f32_16x16x32_bf16 v[60:63], v[220:223], v[232:235], v[60:63]
    s_mov_b64 exec, s[82:83]
    ds_write_b128 v24, v[52:55] offset:8272
    s_mov_b64 exec, -1
    s_mov_b64 exec, s[82:83]
    ds_write_b128 v24, v[56:59] offset:8288
    s_mov_b64 exec, -1
    s_mov_b64 exec, s[82:83]
    s_nop 0
    ds_write_b128 v24, v[60:63] offset:8304
    s_mov_b64 exec, -1
    s_waitcnt lgkmcnt(0)
L_A_y:
    s_barrier
    s_endpgm
L_A_fin:
    s_nop 4
    v_mov_b32 v8, v6
    s_nop 1
    v_permlane16_swap_b32 v6, v8
    v_add_f32 v6, v6, v8
    v_mov_b32 v8, v6
    s_nop 1
    v_permlane32_swap_b32 v6, v8
    v_add_f32 v6, v6, v8
    v_mul_f32 v5, s10, v5
    s_mov_b64 exec, s[82:83]
    ds_write_b32 v25, v5 offset:4608
    ds_write_b32 v25, v6 offset:4736
    ds_write_b128 v24, v[32:35] offset:8192
    ds_write_b128 v24, v[36:39] offset:8208
    ds_write_b128 v24, v[40:43] offset:8224
    ds_write_b128 v24, v[44:47] offset:8240
    ds_write_b128 v24, v[48:51] offset:8256
    ds_write_b128 v24, v[52:55] offset:8272
    ds_write_b128 v24, v[56:59] offset:8288
    ds_write_b128 v24, v[60:63] offset:8304
    s_mov_b64 exec, -1
    s_waitcnt lgkmcnt(0)
    s_barrier
    s_sub_u32 s5, s3, 2
    s_cmp_lt_u32 s5, 4
    s_cbranch_scc1 L_A_y
    ds_read_b128 v[16:19], v27 offset:4608
    ds_read_b128 v[20:23], v27 offset:4624
    ds_read_b128 v[40:43], v27 offset:4736
    ds_read_b128 v[44:47], v27 offset:4752
    ds_read_b128 v[64:67], v26 offset:8192
    ds_read_b128 v[68:71], v26 offset:10240
    ds_read_b128 v[88:91], v26 offset:20480
    ds_read_b128 v[92:95], v26 offset:22528
    s_waitcnt lgkmcnt(6)
    v_max3_f32 v10, v16, v17, v18
    v_max3_f32 v11, v19, v20, v21
    v_max3_f32 v10, v10, v22, v23
    v_max_f32 v10, v10, v11
    v_sub_f32 v16, v16, v10
    v_sub_f32 v17, v17, v10
    v_sub_f32 v18, v18, v10
    v_sub_f32 v19, v19, v10
    v_sub_f32 v20, v20, v10
    v_sub_f32 v21, v21, v10
    v_sub_f32 v22, v22, v10
    v_sub_f32 v23, v23, v10
    v_exp_f32 v16, v16
    v_exp_f32 v17, v17
    v_exp_f32 v18, v18
    v_exp_f32 v19, v19
    v_exp_f32 v20, v20
    v_exp_f32 v21, v21
    v_exp_f32 v22, v22
    v_exp_f32 v23, v23
    s_waitcnt lgkmcnt(0)
    v_mul_f32 v11, v16, v40
    v_fmac_f32 v11, v17, v41
    v_fmac_f32 v11, v18, v42
    v_fmac_f32 v11, v19, v43
    v_fmac_f32 v11, v20, v44
    v_fmac_f32 v11, v21, v45
    v_fmac_f32 v11, v22, v46
    v_fmac_f32 v11, v23, v47
    v_rcp_f32 v13, v11
    v_log_f32 v50, v11
    s_nop 0
    v_add_f32 v50, v50, v10
    v_mul_f32 v96, v16, v13
    v_mul_f32 v98, v17, v13
    v_mul_f32 v100, v18, v13
    v_mul_f32 v102, v19, v13
    v_mul_f32 v104, v20, v13
    v_mul_f32 v106, v21, v13
    v_mul_f32 v108, v22, v13
    v_mul_f32 v110, v23, v13
    v_xor_b32 v51, s4, v50
    v_pk_mul_f32 v[32:33], v[64:65], v[96:97] op_sel_hi:[1,0]
    v_pk_mul_f32 v[34:35], v[66:67], v[96:97] op_sel_hi:[1,0]
    v_pk_fma_f32 v[32:33], v[68:69], v[98:99], v[32:33] op_sel_hi:[1,0,1]
    v_pk_fma_f32 v[34:35], v[70:71], v[98:99], v[34:35] op_sel_hi:[1,0,1]
    v_pk_fma_f32 v[32:33], v[88:89], v[108:109], v[32:33] op_sel_hi:[1,0,1]
    v_pk_fma_f32 v[34:35], v[90:91], v[108:109], v[34:35] op_sel_hi:[1,0,1]
    v_pk_fma_f32 v[32:33], v[92:93], v[110:111], v[32:33] op_sel_hi:[1,0,1]
    v_pk_fma_f32 v[34:35], v[94:95], v[110:111], v[34:35] op_sel_hi:[1,0,1]
    s_mov_b32 exec_hi, 0
    s_barrier
    ds_read_b128 v[72:75], v26 offset:12288
    ds_read_b128 v[76:79], v26 offset:14336
    ds_read_b128 v[80:83], v26 offset:16384
    ds_read_b128 v[84:87], v26 offset:18432
    s_waitcnt lgkmcnt(3)
    v_pk_fma_f32 v[32:33], v[72:73], v[100:101], v[32:33] op_sel_hi:[1,0,1]
    v_pk_fma_f32 v[34:35], v[74:75], v[100:101], v[34:35] op_sel_hi:[1,0,1]
    s_waitcnt lgkmcnt(2)
    v_pk_fma_f32 v[32:33], v[76:77], v[102:103], v[32:33] op_sel_hi:[1,0,1]
    v_pk_fma_f32 v[34:35], v[78:79], v[102:103], v[34:35] op_sel_hi:[1,0,1]
    s_waitcnt lgkmcnt(1)
    v_pk_fma_f32 v[32:33], v[80:81], v[104:105], v[32:33] op_sel_hi:[1,0,1]
    v_pk_fma_f32 v[34:35], v[82:83], v[104:105], v[34:35] op_sel_hi:[1,0,1]
    s_waitcnt lgkmcnt(0)
    v_pk_fma_f32 v[32:33], v[84:85], v[106:107], v[32:33] op_sel_hi:[1,0,1]
    v_pk_fma_f32 v[34:35], v[86:87], v[106:107], v[34:35] op_sel_hi:[1,0,1]
    v_cvt_pk_bf16_f32 v48, v32, v33
    v_cvt_pk_bf16_f32 v49, v34, v35
    v_bitop3_b32 v51, v51, v48, v49 bitop3:0x96
    buffer_store_dwordx4 v[48:51], v28, s[44:47], s77 offen sc1
    s_mov_b64 exec, -1
    s_endpgm
L_A_wn:
    s_barrier
    s_barrier
    buffer_load_dwordx4 v[64:67], v3, s[56:59], s72 offen offset:0 nt
    buffer_load_dwordx4 v[68:71], v3, s[56:59], s72 offen offset:128 nt
    buffer_load_dwordx4 v[72:75], v3, s[56:59], s72 offen offset:512 nt
    buffer_load_dwordx4 v[76:79], v3, s[56:59], s72 offen offset:640 nt
    buffer_load_dwordx4 v[80:83], v3, s[56:59], s72 offen offset:1024 nt
    buffer_load_dwordx4 v[84:87], v3, s[56:59], s72 offen offset:1152 nt
    buffer_load_dwordx4 v[88:91], v3, s[56:59], s72 offen offset:1536 nt
    buffer_load_dwordx4 v[92:95], v3, s[56:59], s72 offen offset:1664 nt
    buffer_load_dwordx4 v[96:99], v4, s[60:63], s72 offen offset:0 nt
    buffer_load_dwordx4 v[100:103], v4, s[60:63], s72 offen offset:256 nt
    buffer_load_dwordx4 v[104:107], v4, s[60:63], s72 offen offset:512 nt
    buffer_load_dwordx4 v[108:111], v4, s[60:63], s72 offen offset:768 nt
    buffer_load_dwordx4 v[112:115], v4, s[60:63], s72 offen offset:1024 nt
    buffer_load_dwordx4 v[116:119], v4, s[60:63], s72 offen offset:1280 nt
    buffer_load_dwordx4 v[120:123], v4, s[60:63], s72 offen offset:1536 nt
    buffer_load_dwordx4 v[124:127], v4, s[60:63], s72 offen offset:1792 nt
    buffer_load_dwordx4 v[128:131], v3, s[56:59], s73 offen offset:0 nt
    buffer_load_dwordx4 v[132:135], v3, s[56:59], s73 offen offset:128 nt
    buffer_load_dwordx4 v[136:139], v3, s[56:59], s73 offen offset:512 nt
    buffer_load_dwordx4 v[140:143], v3, s[56:59], s73 offen offset:640 nt
    buffer_load_dwordx4 v[144:147], v3, s[56:59], s73 offen offset:1024 nt
    buffer_load_dwordx4 v[148:151], v3, s[56:59], s73 offen offset:1152 nt
    buffer_load_dwordx4 v[152:155], v3, s[56:59], s73 offen offset:1536 nt
    buffer_load_dwordx4 v[156:159], v3, s[56:59], s73 offen offset:1664 nt
    buffer_load_dwordx4 v[160:163], v4, s[60:63], s73 offen offset:0 nt
    buffer_load_dwordx4 v[164:167], v4, s[60:63], s73 offen offset:256 nt
    buffer_load_dwordx4 v[168:171], v4, s[60:63], s73 offen offset:512 nt
    buffer_load_dwordx4 v[172:175], v4, s[60:63], s73 offen offset:768 nt
    buffer_load_dwordx4 v[176:179], v4, s[60:63], s73 offen offset:1024 nt
    buffer_load_dwordx4 v[180:183], v4, s[60:63], s73 offen offset:1280 nt
    buffer_load_dwordx4 v[184:187], v4, s[60:63], s73 offen offset:1536 nt
    buffer_load_dwordx4 v[188:191], v4, s[60:63], s73 offen offset:1792 nt
L_A_nopre:
    s_load_dword s4, s[42:43], 0
    s_mov_b32 s44, s42
    s_and_b32 s45, s43, 0xffff
    s_mov_b32 s46, 4718592
    s_mov_b32 s47, 0x00020000
    s_waitcnt lgkmcnt(0)
    s_mul_i32 s4, s4, 0x9E3779B1
    s_add_u32 s4, s4, 0x7F4A7C15
    s_branch L_A_waitq
L_A_p1:
    s_barrier
    s_barrier
    s_load_dword s4, s[42:43], 0
    s_mov_b32 s44, s42
    s_and_b32 s45, s43, 0xffff
    s_mov_b32 s46, 4718592
    s_mov_b32 s47, 0x00020000
    s_waitcnt lgkmcnt(0)
    s_mul_i32 s4, s4, 0x9E3779B1
    s_add_u32 s4, s4, 0x7F4A7C15
    s_branch L_A_fetch
L_B_2:
    s_load_dword s4, s[42:43], 0
    s_mov_b32 s44, s42
    s_and_b32 s45, s43, 0xffff
    s_mov_b32 s46, 4718592
    s_mov_b32 s47, 0x00020000
    v_and_b32 v6, 3, v2
    v_lshlrev_b32 v6, 1, v6
    v_bfe_u32 v7, v2, 2, 1
    v_mul_u32_u24 v7, 9, v7
    v_or_b32 v6, v6, v7
    v_lshlrev_b32 v7, 1, v1
    v_xor_b32 v6, v6, v7
    v_lshrrev_b32 v7, 3, v2
    v_xor_b32 v6, v6, v7
    s_lshr_b32 s5, s3, 1
    s_and_b32 s6, s3, 1
    s_lshl_b32 s7, s5, 15
    v_add_u32 v4, s7, v4
    s_lshl_b32 s7, s6, 12
    v_add_u32 v4, s7, v4
    v_xor_b32 v7, 0, v6
    v_lshl_add_u32 v8, v7, 4, v4
    v_xor_b32 v7, 1, v6
    v_lshl_add_u32 v9, v7, 4, v4
    v_xor_b32 v7, 8, v6
    v_lshl_add_u32 v10, v7, 4, v4
    v_xor_b32 v7, 9, v6
    v_lshl_add_u32 v11, v7, 4, v4
    v_lshlrev_b32 v5, 4, v0
    v_add_u32 v232, 131072, v5
    s_lshl_b32 s7, s5, 11
    s_lshl_b32 s74, s6, 3
    s_add_u32 s7, s7, s74
    v_add_u32 v235, s7, v232
    v_and_b32 v5, 31, v0
    v_lshlrev_b32 v5, 5, v5
    s_lshl_b32 s7, s3, 2
    s_add_u32 s7, s7, 161792
    v_add_u32 v233, s7, v5
    v_lshlrev_b32 v5, 5, v2
    v_add_u32 v234, 161792, v5
    v_lshrrev_b32 v12, 2, v2
    v_lshl_add_u32 v13, v1, 3, v12
    v_lshlrev_b32 v13, 10, v13
    v_and_b32 v14, 1, v2
    v_lshl_add_u32 v13, v14, 3, v13
    s_lshl_b32 s7, s5, 8
    v_add_u32 v13, s7, v13
    v_lshlrev_b32 v12, 1, v12
    v_and_b32 v14, 1, v1
    v_mul_u32_u24 v14, 9, v14
    v_or_b32 v12, v12, v14
    v_bfe_u32 v14, v2, 1, 1
    v_xor_b32 v12, v12, v14
    v_lshrrev_b32 v14, 1, v1
    v_xor_b32 v12, v12, v14
    v_xor_b32 v12, s74, v12
    v_xor_b32 v14, 0, v12
    v_lshl_add_u32 v224, v14, 4, v13
    v_add_u32 v228, 0x10000, v224
    v_xor_b32 v14, 2, v12
    v_lshl_add_u32 v225, v14, 4, v13
    v_add_u32 v229, 0x10000, v225
    v_xor_b32 v14, 4, v12
    v_lshl_add_u32 v226, v14, 4, v13
    v_add_u32 v230, 0x10000, v226
    v_xor_b32 v14, 6, v12
    v_lshl_add_u32 v227, v14, 4, v13
    v_add_u32 v231, 0x10000, v227
    v_lshrrev_b32 v15, 3, v0
    v_and_b32 v5, 7, v0
    v_lshlrev_b32 v238, 15, v15
    v_lshl_add_u32 v238, v5, 4, v238
    v_mul_u32_u24 v237, 144, v15
    v_lshl_add_u32 v237, v5, 4, v237
    v_mul_u32_u24 v236, 144, v2
    v_lshl_add_u32 v236, v1, 3, v236
    s_mul_i32 s7, s3, 4608
    v_add_u32 v236, s7, v236
    v_add_u32 v237, s7, v237
    v_lshlrev_b32 v239, 9, v0
    v_lshlrev_b32 v14, 4, v5
    v_lshl_add_u32 v14, v15, 10, v14
    v_and_b32 v6, 1, v0
    v_lshlrev_b32 v6, 11, v6
    v_bfe_u32 v7, v0, 1, 2
    v_lshl_add_u32 v6, v7, 8, v6
    v_xor_b32 v7, v15, v5
    v_lshl_add_u32 v6, v7, 4, v6
    s_lshl_b32 s7, s3, 13
    s_add_u32 s7, s7, 131072
    v_add_u32 v6, s7, v6
    s_lshr_b32 s5, s71, 5
    s_and_b32 s6, s71, 31
    s_lshl_b32 s76, s5, 15
    s_lshl_b32 s7, s3, 8
    s_add_u32 s76, s76, s7
    s_add_u32 s76, s76, 65536
    s_lshl_b32 s74, s5, 20
    s_lshl_b32 s7, s6, 10
    s_add_u32 s74, s74, s7
    s_lshl_b32 s7, s3, 7
    s_add_u32 s74, s74, s7
    s_add_u32 s74, s74, 2097152
    s_lshl_b32 s77, s71, 3
    s_add_u32 s77, s77, 32768
    s_waitcnt lgkmcnt(0)
    s_mul_i32 s4, s4, 0x9E3779B1
    s_add_u32 s4, s4, 0x7F4A7C15
    s_barrier
    s_cmp_lt_u32 s3, 4
    s_cbranch_scc1 L_B_lo
    s_waitcnt vmcnt(0)
    s_branch L_B_fx0
L_B_lo:
    buffer_load_dwordx4 v[128:131], v3, s[64:67], s73 offen offset:0 nt
    buffer_load_dwordx4 v[132:135], v3, s[64:67], s73 offen offset:1024 nt
    buffer_load_dwordx4 v[136:139], v3, s[64:67], s73 offen offset:128 nt
    buffer_load_dwordx4 v[140:143], v3, s[64:67], s73 offen offset:1152 nt
    buffer_load_dwordx4 v[144:147], v3, s[64:67], s73 offen offset:256 nt
    buffer_load_dwordx4 v[148:151], v3, s[64:67], s73 offen offset:1280 nt
    buffer_load_dwordx4 v[152:155], v3, s[64:67], s73 offen offset:384 nt
    buffer_load_dwordx4 v[156:159], v3, s[64:67], s73 offen offset:1408 nt
    buffer_load_dwordx4 v[160:163], v3, s[64:67], s73 offen offset:512 nt
    buffer_load_dwordx4 v[164:167], v3, s[64:67], s73 offen offset:1536 nt
    buffer_load_dwordx4 v[168:171], v3, s[64:67], s73 offen offset:640 nt
    buffer_load_dwordx4 v[172:175], v3, s[64:67], s73 offen offset:1664 nt
    buffer_load_dwordx4 v[176:179], v3, s[64:67], s73 offen offset:768 nt
    buffer_load_dwordx4 v[180:183], v3, s[64:67], s73 offen offset:1792 nt
    buffer_load_dwordx4 v[184:187], v3, s[64:67], s73 offen offset:896 nt
    buffer_load_dwordx4 v[188:191], v3, s[64:67], s73 offen offset:1920 nt
L_B_fx0:
    s_mov_b32 vcc_lo, 0x55555555
    s_mov_b32 vcc_hi, 0x55555555
    s_waitcnt vmcnt(24)
    v_cndmask_b32_dpp v44, v68, v64, vcc quad_perm:[1,0,3,2] row_mask:0xf bank_mask:0xf
    v_cndmask_b32_dpp v45, v69, v65, vcc quad_perm:[1,0,3,2] row_mask:0xf bank_mask:0xf
    v_cndmask_b32_dpp v46, v70, v66, vcc quad_perm:[1,0,3,2] row_mask:0xf bank_mask:0xf
    v_cndmask_b32_dpp v47, v71, v67, vcc quad_perm:[1,0,3,2] row_mask:0xf bank_mask:0xf
    v_cndmask_b32_dpp v48, v76, v72, vcc quad_perm:[1,0,3,2] row_mask:0xf bank_mask:0xf
    v_cndmask_b32_dpp v49, v77, v73, vcc quad_perm:[1,0,3,2] row_mask:0xf bank_mask:0xf
    v_cndmask_b32_dpp v50, v78, v74, vcc quad_perm:[1,0,3,2] row_mask:0xf bank_mask:0xf
    v_cndmask_b32_dpp v51, v79, v75, vcc quad_perm:[1,0,3,2] row_mask:0xf bank_mask:0xf
    v_cndmask_b32_dpp v52, v84, v80, vcc quad_perm:[1,0,3,2] row_mask:0xf bank_mask:0xf
    v_cndmask_b32_dpp v53, v85, v81, vcc quad_perm:[1,0,3,2] row_mask:0xf bank_mask:0xf
    v_cndmask_b32_dpp v54, v86, v82, vcc quad_perm:[1,0,3,2] row_mask:0xf bank_mask:0xf
    v_cndmask_b32_dpp v55, v87, v83, vcc quad_perm:[1,0,3,2] row_mask:0xf bank_mask:0xf
    v_cndmask_b32_dpp v56, v92, v88, vcc quad_perm:[1,0,3,2] row_mask:0xf bank_mask:0xf
    v_cndmask_b32_dpp v57, v93, v89, vcc quad_perm:[1,0,3,2] row_mask:0xf bank_mask:0xf
    v_cndmask_b32_dpp v58, v94, v90, vcc quad_perm:[1,0,3,2] row_mask:0xf bank_mask:0xf
    v_cndmask_b32_dpp v59, v95, v91, vcc quad_perm:[1,0,3,2] row_mask:0xf bank_mask:0xf
    s_not_b64 vcc, vcc
    v_cndmask_b32_dpp v68, v64, v68, vcc quad_perm:[1,0,3,2] row_mask:0xf bank_mask:0xf
    v_cndmask_b32_dpp v69, v65, v69, vcc quad_perm:[1,0,3,2] row_mask:0xf bank_mask:0xf
    v_cndmask_b32_dpp v70, v66, v70, vcc quad_perm:[1,0,3,2] row_mask:0xf bank_mask:0xf
    v_cndmask_b32_dpp v71, v67, v71, vcc quad_perm:[1,0,3,2] row_mask:0xf bank_mask:0xf
    v_cndmask_b32_dpp v76, v72, v76, vcc quad_perm:[1,0,3,2] row_mask:0xf bank_mask:0xf
    v_cndmask_b32_dpp v77, v73, v77, vcc quad_perm:[1,0,3,2] row_mask:0xf bank_mask:0xf
    v_cndmask_b32_dpp v78, v74, v78, vcc quad_perm:[1,0,3,2] row_mask:0xf bank_mask:0xf
    v_cndmask_b32_dpp v79, v75, v79, vcc quad_perm:[1,0,3,2] row_mask:0xf bank_mask:0xf
    v_cndmask_b32_dpp v84, v80, v84, vcc quad_perm:[1,0,3,2] row_mask:0xf bank_mask:0xf
    v_cndmask_b32_dpp v85, v81, v85, vcc quad_perm:[1,0,3,2] row_mask:0xf bank_mask:0xf
    v_cndmask_b32_dpp v86, v82, v86, vcc quad_perm:[1,0,3,2] row_mask:0xf bank_mask:0xf
    v_cndmask_b32_dpp v87, v83, v87, vcc quad_perm:[1,0,3,2] row_mask:0xf bank_mask:0xf
    v_cndmask_b32_dpp v92, v88, v92, vcc quad_perm:[1,0,3,2] row_mask:0xf bank_mask:0xf
    v_cndmask_b32_dpp v93, v89, v93, vcc quad_perm:[1,0,3,2] row_mask:0xf bank_mask:0xf
    v_cndmask_b32_dpp v94, v90, v94, vcc quad_perm:[1,0,3,2] row_mask:0xf bank_mask:0xf
    v_cndmask_b32_dpp v95, v91, v95, vcc quad_perm:[1,0,3,2] row_mask:0xf bank_mask:0xf
    s_mov_b32 vcc_lo, 0x55555555
    s_mov_b32 vcc_hi, 0x55555555
    s_waitcnt vmcnt(16)
    v_cndmask_b32_dpp v64, v100, v96, vcc quad_perm:[1,0,3,2] row_mask:0xf bank_mask:0xf
    v_cndmask_b32_dpp v65, v101, v97, vcc quad_perm:[1,0,3,2] row_mask:0xf bank_mask:0xf
    v_cndmask_b32_dpp v66, v102, v98, vcc quad_perm:[1,0,3,2] row_mask:0xf bank_mask:0xf
    v_cndmask_b32_dpp v67, v103, v99, vcc quad_perm:[1,0,3,2] row_mask:0xf bank_mask:0xf
    v_cndmask_b32_dpp v72, v108, v104, vcc quad_perm:[1,0,3,2] row_mask:0xf bank_mask:0xf
    v_cndmask_b32_dpp v73, v109, v105, vcc quad_perm:[1,0,3,2] row_mask:0xf bank_mask:0xf
    v_cndmask_b32_dpp v74, v110, v106, vcc quad_perm:[1,0,3,2] row_mask:0xf bank_mask:0xf
    v_cndmask_b32_dpp v75, v111, v107, vcc quad_perm:[1,0,3,2] row_mask:0xf bank_mask:0xf
    v_cndmask_b32_dpp v80, v116, v112, vcc quad_perm:[1,0,3,2] row_mask:0xf bank_mask:0xf
    v_cndmask_b32_dpp v81, v117, v113, vcc quad_perm:[1,0,3,2] row_mask:0xf bank_mask:0xf
    v_cndmask_b32_dpp v82, v118, v114, vcc quad_perm:[1,0,3,2] row_mask:0xf bank_mask:0xf
    v_cndmask_b32_dpp v83, v119, v115, vcc quad_perm:[1,0,3,2] row_mask:0xf bank_mask:0xf
    v_cndmask_b32_dpp v88, v124, v120, vcc quad_perm:[1,0,3,2] row_mask:0xf bank_mask:0xf
    v_cndmask_b32_dpp v89, v125, v121, vcc quad_perm:[1,0,3,2] row_mask:0xf bank_mask:0xf
    v_cndmask_b32_dpp v90, v126, v122, vcc quad_perm:[1,0,3,2] row_mask:0xf bank_mask:0xf
    v_cndmask_b32_dpp v91, v127, v123, vcc quad_perm:[1,0,3,2] row_mask:0xf bank_mask:0xf
    s_not_b64 vcc, vcc
    v_cndmask_b32_dpp v100, v96, v100, vcc quad_perm:[1,0,3,2] row_mask:0xf bank_mask:0xf
    v_cndmask_b32_dpp v101, v97, v101, vcc quad_perm:[1,0,3,2] row_mask:0xf bank_mask:0xf
    v_cndmask_b32_dpp v102, v98, v102, vcc quad_perm:[1,0,3,2] row_mask:0xf bank_mask:0xf
    v_cndmask_b32_dpp v103, v99, v103, vcc quad_perm:[1,0,3,2] row_mask:0xf bank_mask:0xf
    v_cndmask_b32_dpp v108, v104, v108, vcc quad_perm:[1,0,3,2] row_mask:0xf bank_mask:0xf
    v_cndmask_b32_dpp v109, v105, v109, vcc quad_perm:[1,0,3,2] row_mask:0xf bank_mask:0xf
    v_cndmask_b32_dpp v110, v106, v110, vcc quad_perm:[1,0,3,2] row_mask:0xf bank_mask:0xf
    v_cndmask_b32_dpp v111, v107, v111, vcc quad_perm:[1,0,3,2] row_mask:0xf bank_mask:0xf
    v_cndmask_b32_dpp v116, v112, v116, vcc quad_perm:[1,0,3,2] row_mask:0xf bank_mask:0xf
    v_cndmask_b32_dpp v117, v113, v117, vcc quad_perm:[1,0,3,2] row_mask:0xf bank_mask:0xf
    v_cndmask_b32_dpp v118, v114, v118, vcc quad_perm:[1,0,3,2] row_mask:0xf bank_mask:0xf
    v_cndmask_b32_dpp v119, v115, v119, vcc quad_perm:[1,0,3,2] row_mask:0xf bank_mask:0xf
    v_cndmask_b32_dpp v124, v120, v124, vcc quad_perm:[1,0,3,2] row_mask:0xf bank_mask:0xf
    v_cndmask_b32_dpp v125, v121, v125, vcc quad_perm:[1,0,3,2] row_mask:0xf bank_mask:0xf
    v_cndmask_b32_dpp v126, v122, v126, vcc quad_perm:[1,0,3,2] row_mask:0xf bank_mask:0xf
    v_cndmask_b32_dpp v127, v123, v127, vcc quad_perm:[1,0,3,2] row_mask:0xf bank_mask:0xf
    ds_write_b128 v8, v[44:47] offset:0
    ds_write_b128 v9, v[68:71] offset:0
    ds_write_b128 v10, v[48:51] offset:0
    ds_write_b128 v11, v[76:79] offset:0
    ds_write_b128 v8, v[52:55] offset:256
    ds_write_b128 v9, v[84:87] offset:256
    ds_write_b128 v10, v[56:59] offset:256
    ds_write_b128 v11, v[92:95] offset:256
    ds_write_b128 v8, v[64:67] offset:512
    ds_write_b128 v9, v[100:103] offset:512
    ds_write_b128 v10, v[72:75] offset:512
    ds_write_b128 v11, v[108:111] offset:512
    ds_write_b128 v8, v[80:83] offset:768
    ds_write_b128 v9, v[116:119] offset:768
    ds_write_b128 v10, v[88:91] offset:768
    ds_write_b128 v11, v[124:127] offset:768
    s_cmp_lt_u32 s3, 4
    s_cbranch_scc1 L_B_fetch
    s_cmp_lg_u32 s3, 4
    s_cbranch_scc1 L_B_nt
    v_lshlrev_b32 v12, 7, v0
    s_lshl_b32 s5, s71, 13
    s_add_u32 s5, s5, 1048576
    buffer_load_dword v27, v12, s[44:47], s5 offen sc1
L_B_nt:
    s_mov_b32 s11, 160000
L_B_hw:
    ds_read_b32 v13, v26
    s_waitcnt lgkmcnt(0)
    v_cmp_eq_u32 vcc, -1, v13
    s_cbranch_vccz L_B_hwd
    s_sleep 1
    s_sub_u32 s11, s11, 1
    s_cmp_gt_i32 s11, 0
    s_cbranch_scc1 L_B_hw
L_B_hwd:
    buffer_load_dwordx4 v[128:131], v3, s[64:67], s73 offen offset:0 nt
    buffer_load_dwordx4 v[132:135], v3, s[64:67], s73 offen offset:1024 nt
    buffer_load_dwordx4 v[136:139], v3, s[64:67], s73 offen offset:128 nt
    buffer_load_dwordx4 v[140:143], v3, s[64:67], s73 offen offset:1152 nt
    buffer_load_dwordx4 v[144:147], v3, s[64:67], s73 offen offset:256 nt
    buffer_load_dwordx4 v[148:151], v3, s[64:67], s73 offen offset:1280 nt
    buffer_load_dwordx4 v[152:155], v3, s[64:67], s73 offen offset:384 nt
    buffer_load_dwordx4 v[156:159], v3, s[64:67], s73 offen offset:1408 nt
    s_branch L_B_nofetch
L_B_fetch:
    s_and_b32 s6, s71, 7
    s_lshl_b32 s6, s6, 8
    s_lshr_b32 s5, s3, 1
    s_lshl_b32 s5, s5, 7
    s_add_u32 s6, s6, s5
    s_add_u32 s6, s6, 16384
    s_add_u32 s80, s42, s6
    s_addc_u32 s81, s43, 0
    s_mov_b32 s78, s4
    s_mov_b32 s79, s4
    s_mov_b32 s11, 80000
L_B_p2_0:
    s_load_dwordx16 s[48:63], s[80:81], 0 glc
    s_waitcnt lgkmcnt(0)
    s_xor_b64 s[48:49], s[48:49], s[78:79]
    s_xor_b64 s[50:51], s[50:51], s[78:79]
    s_or_b64 s[48:49], s[48:49], s[50:51]
    s_xor_b64 s[52:53], s[52:53], s[78:79]
    s_or_b64 s[48:49], s[48:49], s[52:53]
    s_xor_b64 s[54:55], s[54:55], s[78:79]
    s_or_b64 s[48:49], s[48:49], s[54:55]
    s_xor_b64 s[56:57], s[56:57], s[78:79]
    s_or_b64 s[48:49], s[48:49], s[56:57]
    s_xor_b64 s[58:59], s[58:59], s[78:79]
    s_or_b64 s[48:49], s[48:49], s[58:59]
    s_xor_b64 s[60:61], s[60:61], s[78:79]
    s_or_b64 s[48:49], s[48:49], s[60:61]
    s_xor_b64 s[62:63], s[62:63], s[78:79]
    s_or_b64 s[48:49], s[48:49], s[62:63]
    s_cbranch_scc0 L_B_p2d_0
    s_sleep 2
    s_sub_u32 s11, s11, 1
    s_cmp_gt_i32 s11, 0
    s_cbranch_scc1 L_B_p2_0
L_B_p2d_0:
L_B_p2_1:
    s_load_dwordx16 s[48:63], s[80:81], 64 glc
    s_waitcnt lgkmcnt(0)
    s_xor_b64 s[48:49], s[48:49], s[78:79]
    s_xor_b64 s[50:51], s[50:51], s[78:79]
    s_or_b64 s[48:49], s[48:49], s[50:51]
    s_xor_b64 s[52:53], s[52:53], s[78:79]
    s_or_b64 s[48:49], s[48:49], s[52:53]
    s_xor_b64 s[54:55], s[54:55], s[78:79]
    s_or_b64 s[48:49], s[48:49], s[54:55]
    s_xor_b64 s[56:57], s[56:57], s[78:79]
    s_or_b64 s[48:49], s[48:49], s[56:57]
    s_xor_b64 s[58:59], s[58:59], s[78:79]
    s_or_b64 s[48:49], s[48:49], s[58:59]
    s_xor_b64 s[60:61], s[60:61], s[78:79]
    s_or_b64 s[48:49], s[48:49], s[60:61]
    s_xor_b64 s[62:63], s[62:63], s[78:79]
    s_or_b64 s[48:49], s[48:49], s[62:63]
    s_cbranch_scc0 L_B_p2d_1
    s_sleep 2
    s_sub_u32 s11, s11, 1
    s_cmp_gt_i32 s11, 0
    s_cbranch_scc1 L_B_p2_1
L_B_p2d_1:
    s_add_u32 s75, s76, 0
    buffer_load_dwordx4 v[192:195], v14, s[44:47], s75 offen offset:0 sc1
    buffer_load_dwordx4 v[196:199], v14, s[44:47], s75 offen offset:128 sc1
    s_add_u32 s75, s76, 8192
    buffer_load_dwordx4 v[200:203], v14, s[44:47], s75 offen offset:0 sc1
    buffer_load_dwordx4 v[204:207], v14, s[44:47], s75 offen offset:128 sc1
    s_add_u32 s75, s76, 16384
    buffer_load_dwordx4 v[208:211], v14, s[44:47], s75 offen offset:0 sc1
    buffer_load_dwordx4 v[212:215], v14, s[44:47], s75 offen offset:128 sc1
    s_add_u32 s75, s76, 24576
    buffer_load_dwordx4 v[216:219], v14, s[44:47], s75 offen offset:0 sc1
    buffer_load_dwordx4 v[220:223], v14, s[44:47], s75 offen offset:128 sc1
    s_lshl_b32 s5, s3, 13
    s_add_u32 s5, s5, 131072
    v_mov_b32 v12, s5
    v_mov_b32 v13, 0
    ds_write_b32 v12, v13
    s_mov_b32 vcc_lo, 0x55555555
    s_mov_b32 vcc_hi, 0x55555555
    s_waitcnt vmcnt(16)
    v_cndmask_b32_dpp v96, v132, v128, vcc quad_perm:[1,0,3,2] row_mask:0xf bank_mask:0xf
    v_cndmask_b32_dpp v97, v133, v129, vcc quad_perm:[1,0,3,2] row_mask:0xf bank_mask:0xf
    v_cndmask_b32_dpp v98, v134, v130, vcc quad_perm:[1,0,3,2] row_mask:0xf bank_mask:0xf
    v_cndmask_b32_dpp v99, v135, v131, vcc quad_perm:[1,0,3,2] row_mask:0xf bank_mask:0xf
    v_cndmask_b32_dpp v104, v140, v136, vcc quad_perm:[1,0,3,2] row_mask:0xf bank_mask:0xf
    v_cndmask_b32_dpp v105, v141, v137, vcc quad_perm:[1,0,3,2] row_mask:0xf bank_mask:0xf
    v_cndmask_b32_dpp v106, v142, v138, vcc quad_perm:[1,0,3,2] row_mask:0xf bank_mask:0xf
    v_cndmask_b32_dpp v107, v143, v139, vcc quad_perm:[1,0,3,2] row_mask:0xf bank_mask:0xf
    v_cndmask_b32_dpp v112, v148, v144, vcc quad_perm:[1,0,3,2] row_mask:0xf bank_mask:0xf
    v_cndmask_b32_dpp v113, v149, v145, vcc quad_perm:[1,0,3,2] row_mask:0xf bank_mask:0xf
    v_cndmask_b32_dpp v114, v150, v146, vcc quad_perm:[1,0,3,2] row_mask:0xf bank_mask:0xf
    v_cndmask_b32_dpp v115, v151, v147, vcc quad_perm:[1,0,3,2] row_mask:0xf bank_mask:0xf
    v_cndmask_b32_dpp v120, v156, v152, vcc quad_perm:[1,0,3,2] row_mask:0xf bank_mask:0xf
    v_cndmask_b32_dpp v121, v157, v153, vcc quad_perm:[1,0,3,2] row_mask:0xf bank_mask:0xf
    v_cndmask_b32_dpp v122, v158, v154, vcc quad_perm:[1,0,3,2] row_mask:0xf bank_mask:0xf
    v_cndmask_b32_dpp v123, v159, v155, vcc quad_perm:[1,0,3,2] row_mask:0xf bank_mask:0xf
    s_not_b64 vcc, vcc
    v_cndmask_b32_dpp v132, v128, v132, vcc quad_perm:[1,0,3,2] row_mask:0xf bank_mask:0xf
    v_cndmask_b32_dpp v133, v129, v133, vcc quad_perm:[1,0,3,2] row_mask:0xf bank_mask:0xf
    v_cndmask_b32_dpp v134, v130, v134, vcc quad_perm:[1,0,3,2] row_mask:0xf bank_mask:0xf
    v_cndmask_b32_dpp v135, v131, v135, vcc quad_perm:[1,0,3,2] row_mask:0xf bank_mask:0xf
    v_cndmask_b32_dpp v140, v136, v140, vcc quad_perm:[1,0,3,2] row_mask:0xf bank_mask:0xf
    v_cndmask_b32_dpp v141, v137, v141, vcc quad_perm:[1,0,3,2] row_mask:0xf bank_mask:0xf
    v_cndmask_b32_dpp v142, v138, v142, vcc quad_perm:[1,0,3,2] row_mask:0xf bank_mask:0xf
    v_cndmask_b32_dpp v143, v139, v143, vcc quad_perm:[1,0,3,2] row_mask:0xf bank_mask:0xf
    v_cndmask_b32_dpp v148, v144, v148, vcc quad_perm:[1,0,3,2] row_mask:0xf bank_mask:0xf
    v_cndmask_b32_dpp v149, v145, v149, vcc quad_perm:[1,0,3,2] row_mask:0xf bank_mask:0xf
    v_cndmask_b32_dpp v150, v146, v150, vcc quad_perm:[1,0,3,2] row_mask:0xf bank_mask:0xf
    v_cndmask_b32_dpp v151, v147, v151, vcc quad_perm:[1,0,3,2] row_mask:0xf bank_mask:0xf
    v_cndmask_b32_dpp v156, v152, v156, vcc quad_perm:[1,0,3,2] row_mask:0xf bank_mask:0xf
    v_cndmask_b32_dpp v157, v153, v157, vcc quad_perm:[1,0,3,2] row_mask:0xf bank_mask:0xf
    v_cndmask_b32_dpp v158, v154, v158, vcc quad_perm:[1,0,3,2] row_mask:0xf bank_mask:0xf
    v_cndmask_b32_dpp v159, v155, v159, vcc quad_perm:[1,0,3,2] row_mask:0xf bank_mask:0xf
    s_mov_b32 vcc_lo, 0x55555555
    s_mov_b32 vcc_hi, 0x55555555
    s_waitcnt vmcnt(8)
    v_cndmask_b32_dpp v128, v164, v160, vcc quad_perm:[1,0,3,2] row_mask:0xf bank_mask:0xf
    v_cndmask_b32_dpp v129, v165, v161, vcc quad_perm:[1,0,3,2] row_mask:0xf bank_mask:0xf
    v_cndmask_b32_dpp v130, v166, v162, vcc quad_perm:[1,0,3,2] row_mask:0xf bank_mask:0xf
    v_cndmask_b32_dpp v131, v167, v163, vcc quad_perm:[1,0,3,2] row_mask:0xf bank_mask:0xf
    v_cndmask_b32_dpp v136, v172, v168, vcc quad_perm:[1,0,3,2] row_mask:0xf bank_mask:0xf
    v_cndmask_b32_dpp v137, v173, v169, vcc quad_perm:[1,0,3,2] row_mask:0xf bank_mask:0xf
    v_cndmask_b32_dpp v138, v174, v170, vcc quad_perm:[1,0,3,2] row_mask:0xf bank_mask:0xf
    v_cndmask_b32_dpp v139, v175, v171, vcc quad_perm:[1,0,3,2] row_mask:0xf bank_mask:0xf
    v_cndmask_b32_dpp v144, v180, v176, vcc quad_perm:[1,0,3,2] row_mask:0xf bank_mask:0xf
    v_cndmask_b32_dpp v145, v181, v177, vcc quad_perm:[1,0,3,2] row_mask:0xf bank_mask:0xf
    v_cndmask_b32_dpp v146, v182, v178, vcc quad_perm:[1,0,3,2] row_mask:0xf bank_mask:0xf
    v_cndmask_b32_dpp v147, v183, v179, vcc quad_perm:[1,0,3,2] row_mask:0xf bank_mask:0xf
    v_cndmask_b32_dpp v152, v188, v184, vcc quad_perm:[1,0,3,2] row_mask:0xf bank_mask:0xf
    v_cndmask_b32_dpp v153, v189, v185, vcc quad_perm:[1,0,3,2] row_mask:0xf bank_mask:0xf
    v_cndmask_b32_dpp v154, v190, v186, vcc quad_perm:[1,0,3,2] row_mask:0xf bank_mask:0xf
    v_cndmask_b32_dpp v155, v191, v187, vcc quad_perm:[1,0,3,2] row_mask:0xf bank_mask:0xf
    s_not_b64 vcc, vcc
    v_cndmask_b32_dpp v164, v160, v164, vcc quad_perm:[1,0,3,2] row_mask:0xf bank_mask:0xf
    v_cndmask_b32_dpp v165, v161, v165, vcc quad_perm:[1,0,3,2] row_mask:0xf bank_mask:0xf
    v_cndmask_b32_dpp v166, v162, v166, vcc quad_perm:[1,0,3,2] row_mask:0xf bank_mask:0xf
    v_cndmask_b32_dpp v167, v163, v167, vcc quad_perm:[1,0,3,2] row_mask:0xf bank_mask:0xf
    v_cndmask_b32_dpp v172, v168, v172, vcc quad_perm:[1,0,3,2] row_mask:0xf bank_mask:0xf
    v_cndmask_b32_dpp v173, v169, v173, vcc quad_perm:[1,0,3,2] row_mask:0xf bank_mask:0xf
    v_cndmask_b32_dpp v174, v170, v174, vcc quad_perm:[1,0,3,2] row_mask:0xf bank_mask:0xf
    v_cndmask_b32_dpp v175, v171, v175, vcc quad_perm:[1,0,3,2] row_mask:0xf bank_mask:0xf
    v_cndmask_b32_dpp v180, v176, v180, vcc quad_perm:[1,0,3,2] row_mask:0xf bank_mask:0xf
    v_cndmask_b32_dpp v181, v177, v181, vcc quad_perm:[1,0,3,2] row_mask:0xf bank_mask:0xf
    v_cndmask_b32_dpp v182, v178, v182, vcc quad_perm:[1,0,3,2] row_mask:0xf bank_mask:0xf
    v_cndmask_b32_dpp v183, v179, v183, vcc quad_perm:[1,0,3,2] row_mask:0xf bank_mask:0xf
    v_cndmask_b32_dpp v188, v184, v188, vcc quad_perm:[1,0,3,2] row_mask:0xf bank_mask:0xf
    v_cndmask_b32_dpp v189, v185, v189, vcc quad_perm:[1,0,3,2] row_mask:0xf bank_mask:0xf
    v_cndmask_b32_dpp v190, v186, v190, vcc quad_perm:[1,0,3,2] row_mask:0xf bank_mask:0xf
    v_cndmask_b32_dpp v191, v187, v191, vcc quad_perm:[1,0,3,2] row_mask:0xf bank_mask:0xf
    s_waitcnt vmcnt(7)
    ds_write_b128 v6, v[192:195] offset:0
    s_waitcnt vmcnt(6)
    ds_write_b128 v6, v[196:199] offset:4096
    s_waitcnt vmcnt(5)
    ds_write_b128 v6, v[200:203] offset:128
    s_waitcnt vmcnt(4)
    ds_write_b128 v6, v[204:207] offset:4224
    s_waitcnt vmcnt(3)
    ds_write_b128 v6, v[208:211] offset:1024
    s_waitcnt vmcnt(2)
    ds_write_b128 v6, v[212:215] offset:5120
    s_waitcnt vmcnt(1)
    ds_write_b128 v6, v[216:219] offset:1152
    s_waitcnt vmcnt(0)
    s_mov_b32 exec_hi, 0x7fffffff
    ds_write_b128 v6, v[220:223] offset:5248
    s_mov_b32 exec_lo, 0
    s_mov_b32 exec_hi, 0x80000000
    ds_write_b128 v6, v[220:223] offset:5248
    s_mov_b64 exec, -1
L_B_nofetch:
    s_mov_b32 s11, 160000
L_B_lw:
    ds_read_b32 v13, v26 offset:8064
    s_waitcnt lgkmcnt(0)
    v_cmp_eq_u32 vcc, -1, v13
    s_cbranch_vccz L_B_lwd
    s_sleep 1
    s_sub_u32 s11, s11, 1
    s_cmp_gt_i32 s11, 0
    s_cbranch_scc1 L_B_lw
L_B_lwd:
    v_lshlrev_b32 v6, 5, v1
    v_xor_b32 v6, v6, v232
    v_xor_b32 v7, 16, v6
    ds_read_b128 v[192:195], v6 offset:0
    ds_read_b128 v[196:199], v6 offset:1024
    ds_read_b128 v[200:203], v7 offset:2048
    ds_read_b128 v[204:207], v7 offset:3072
    ds_read_b128 v[208:211], v6 offset:4096
    ds_read_b128 v[212:215], v6 offset:5120
    ds_read_b128 v[216:219], v7 offset:6144
    ds_read_b128 v[220:223], v7 offset:7168
    s_waitcnt lgkmcnt(6)
    v_mfma_f32_16x16x32_bf16 v[12:15], v[44:47], v[192:195], 0
    v_mfma_f32_16x16x32_bf16 v[16:19], v[44:47], v[196:199], 0
    ds_read_b128 v[192:195], v6 offset:8192
    ds_read_b128 v[196:199], v6 offset:9216
    s_waitcnt lgkmcnt(6)
    v_mfma_f32_16x16x32_bf16 v[12:15], v[68:71], v[200:203], v[12:15]
    v_mfma_f32_16x16x32_bf16 v[16:19], v[68:71], v[204:207], v[16:19]
    ds_read_b128 v[200:203], v7 offset:10240
    ds_read_b128 v[204:207], v7 offset:11264
    s_waitcnt lgkmcnt(6)
    v_mfma_f32_16x16x32_bf16 v[12:15], v[48:51], v[208:211], v[12:15]
    v_mfma_f32_16x16x32_bf16 v[16:19], v[48:51], v[212:215], v[16:19]
    ds_read_b128 v[208:211], v6 offset:12288
    ds_read_b128 v[212:215], v6 offset:13312
    s_waitcnt lgkmcnt(6)
    v_mfma_f32_16x16x32_bf16 v[12:15], v[76:79], v[216:219], v[12:15]
    v_mfma_f32_16x16x32_bf16 v[16:19], v[76:79], v[220:223], v[16:19]
    ds_read_b128 v[216:219], v7 offset:14336
    ds_read_b128 v[220:223], v7 offset:15360
    s_waitcnt lgkmcnt(6)
    v_mfma_f32_16x16x32_bf16 v[12:15], v[52:55], v[192:195], v[12:15]
    v_mfma_f32_16x16x32_bf16 v[16:19], v[52:55], v[196:199], v[16:19]
    ds_read_b128 v[192:195], v6 offset:16384
    ds_read_b128 v[196:199], v6 offset:17408
    s_waitcnt lgkmcnt(6)
    v_mfma_f32_16x16x32_bf16 v[12:15], v[84:87], v[200:203], v[12:15]
    v_mfma_f32_16x16x32_bf16 v[16:19], v[84:87], v[204:207], v[16:19]
    ds_read_b128 v[200:203], v7 offset:18432
    ds_read_b128 v[204:207], v7 offset:19456
    s_waitcnt lgkmcnt(6)
    v_mfma_f32_16x16x32_bf16 v[12:15], v[56:59], v[208:211], v[12:15]
    v_mfma_f32_16x16x32_bf16 v[16:19], v[56:59], v[212:215], v[16:19]
    ds_read_b128 v[208:211], v6 offset:20480
    ds_read_b128 v[212:215], v6 offset:21504
    s_waitcnt lgkmcnt(6)
    v_mfma_f32_16x16x32_bf16 v[12:15], v[92:95], v[216:219], v[12:15]
    v_mfma_f32_16x16x32_bf16 v[16:19], v[92:95], v[220:223], v[16:19]
    ds_read_b128 v[60:63], v7 offset:22528
    ds_read_b128 v[68:71], v7 offset:23552
    s_waitcnt lgkmcnt(6)
    v_mfma_f32_16x16x32_bf16 v[12:15], v[64:67], v[192:195], v[12:15]
    v_mfma_f32_16x16x32_bf16 v[16:19], v[64:67], v[196:199], v[16:19]
    ds_read_b128 v[76:79], v6 offset:24576
    ds_read_b128 v[84:87], v6 offset:25600
    s_waitcnt lgkmcnt(6)
    v_mfma_f32_16x16x32_bf16 v[12:15], v[100:103], v[200:203], v[12:15]
    v_mfma_f32_16x16x32_bf16 v[16:19], v[100:103], v[204:207], v[16:19]
    ds_read_b128 v[92:95], v7 offset:26624
    ds_read_b128 v[64:67], v7 offset:27648
    s_waitcnt lgkmcnt(6)
    v_mfma_f32_16x16x32_bf16 v[12:15], v[72:75], v[208:211], v[12:15]
    v_mfma_f32_16x16x32_bf16 v[16:19], v[72:75], v[212:215], v[16:19]
    ds_read_b128 v[100:103], v6 offset:28672
    ds_read_b128 v[72:75], v6 offset:29696
    s_waitcnt lgkmcnt(6)
    v_mfma_f32_16x16x32_bf16 v[12:15], v[108:111], v[60:63], v[12:15]
    v_mfma_f32_16x16x32_bf16 v[16:19], v[108:111], v[68:71], v[16:19]
    ds_read_b128 v[108:111], v7 offset:30720
    ds_read_b128 v[252:255], v7 offset:31744
    s_waitcnt lgkmcnt(6)
    v_mfma_f32_16x16x32_bf16 v[12:15], v[80:83], v[76:79], v[12:15]
    v_mfma_f32_16x16x32_bf16 v[16:19], v[80:83], v[84:87], v[16:19]
    s_waitcnt lgkmcnt(4)
    v_mfma_f32_16x16x32_bf16 v[12:15], v[116:119], v[92:95], v[12:15]
    v_mfma_f32_16x16x32_bf16 v[16:19], v[116:119], v[64:67], v[16:19]
    s_waitcnt lgkmcnt(2)
    v_mfma_f32_16x16x32_bf16 v[12:15], v[88:91], v[100:103], v[12:15]
    v_mfma_f32_16x16x32_bf16 v[16:19], v[88:91], v[72:75], v[16:19]
    s_waitcnt lgkmcnt(0)
    v_mfma_f32_16x16x32_bf16 v[12:15], v[124:127], v[108:111], v[12:15]
    v_mfma_f32_16x16x32_bf16 v[16:19], v[124:127], v[252:255], v[16:19]
    s_cmp_lt_u32 s3, 4
    s_cbranch_scc1 L_B_nl
    buffer_load_dwordx4 v[160:163], v3, s[64:67], s73 offen offset:512 nt
    buffer_load_dwordx4 v[164:167], v3, s[64:67], s73 offen offset:1536 nt
    buffer_load_dwordx4 v[168:171], v3, s[64:67], s73 offen offset:640 nt
    buffer_load_dwordx4 v[172:175], v3, s[64:67], s73 offen offset:1664 nt
    buffer_load_dwordx4 v[176:179], v3, s[64:67], s73 offen offset:768 nt
    buffer_load_dwordx4 v[180:183], v3, s[64:67], s73 offen offset:1792 nt
    buffer_load_dwordx4 v[184:187], v3, s[64:67], s73 offen offset:896 nt
    buffer_load_dwordx4 v[188:191], v3, s[64:67], s73 offen offset:1920 nt
L_B_nl:
    s_nop 7
    v_max3_f32 v4, v12, v13, v14
    v_max_f32 v4, v4, v15
    v_max3_f32 v5, v16, v17, v18
    v_max_f32 v5, v5, v19
    s_nop 1
    v_permlane16_swap_b32 v4, v5
    v_max_f32 v4, v4, v5
    v_mov_b32 v5, v4
    s_nop 1
    v_permlane32_swap_b32 v4, v5
    v_max_f32 v4, v4, v5
    s_barrier
    ds_write_b32 v233, v4 offset:1024
    s_waitcnt lgkmcnt(0)
    s_barrier
    ds_read_b128 v[192:195], v234 offset:1024
    ds_read_b128 v[196:199], v234 offset:1040
    ds_read_b128 v[200:203], v234 offset:1536
    ds_read_b128 v[204:207], v234 offset:1552
    s_waitcnt lgkmcnt(2)
    v_max3_f32 v4, v192, v193, v194
    v_max3_f32 v5, v195, v196, v197
    v_max3_f32 v4, v4, v198, v199
    v_max_f32 v22, v4, v5
    v_mul_f32 v24, s10, v22
    v_fma_f32 v12, v12, s10, -v24
    v_fma_f32 v13, v13, s10, -v24
    v_fma_f32 v14, v14, s10, -v24
    v_fma_f32 v15, v15, s10, -v24
    v_exp_f32 v12, v12
    v_exp_f32 v13, v13
    v_exp_f32 v14, v14
    v_exp_f32 v15, v15
    s_waitcnt lgkmcnt(0)
    v_max3_f32 v4, v200, v201, v202
    v_max3_f32 v5, v203, v204, v205
    v_max3_f32 v4, v4, v206, v207
    v_max_f32 v23, v4, v5
    v_mul_f32 v25, s10, v23
    v_fma_f32 v16, v16, s10, -v25
    v_fma_f32 v17, v17, s10, -v25
    v_fma_f32 v18, v18, s10, -v25
    v_fma_f32 v19, v19, s10, -v25
    v_exp_f32 v16, v16
    v_exp_f32 v17, v17
    v_exp_f32 v18, v18
    v_exp_f32 v19, v19
    v_cvt_pk_bf16_f32 v192, v12, v13
    v_cvt_pk_bf16_f32 v193, v14, v15
    ds_write_b64 v235, v[192:193] offset:22528
    v_cvt_pk_bf16_f32 v194, v16, v17
    v_cvt_pk_bf16_f32 v195, v18, v19
    ds_write_b64 v235, v[194:195] offset:23552
    s_waitcnt lgkmcnt(0)
    s_barrier
    ds_read_b128 v[192:195], v232 offset:22528
    ds_read_b128 v[196:199], v232 offset:23552
    ds_read_b64_tr_b16 v[240:241], v224 offset:0
    ds_read_b64_tr_b16 v[242:243], v224 offset:4096
    ds_read_b64_tr_b16 v[244:245], v225 offset:0
    ds_read_b64_tr_b16 v[246:247], v225 offset:4096
    ds_read_b64_tr_b16 v[248:249], v226 offset:0
    ds_read_b64_tr_b16 v[250:251], v226 offset:4096
    ds_read_b64_tr_b16 v[80:81], v227 offset:0
    ds_read_b64_tr_b16 v[82:83], v227 offset:4096
    ds_read_b128 v[200:203], v232 offset:24576
    ds_read_b128 v[204:207], v232 offset:25600
    ds_read_b64_tr_b16 v[116:117], v224 offset:32768
    ds_read_b64_tr_b16 v[118:119], v224 offset:36864
    ds_read_b64_tr_b16 v[88:89], v225 offset:32768
    ds_read_b64_tr_b16 v[90:91], v225 offset:36864
    v_add_f32 v12, v12, v13
    v_add_f32 v14, v14, v15
    v_add_f32 v20, v12, v14
    v_add_f32 v16, v16, v17
    v_add_f32 v18, v18, v19
    v_add_f32 v21, v16, v18
    ds_read_b64_tr_b16 v[124:125], v226 offset:32768
    ds_read_b64_tr_b16 v[126:127], v226 offset:36864
    s_waitcnt lgkmcnt(14)
    v_mfma_f32_16x16x32_bf16 v[28:31], v[240:243], v[192:195], 0
    v_mfma_f32_16x16x32_bf16 v[32:35], v[240:243], v[196:199], 0
    ds_read_b64_tr_b16 v[240:241], v227 offset:32768
    ds_read_b64_tr_b16 v[242:243], v227 offset:36864
    s_waitcnt lgkmcnt(14)
    v_mfma_f32_16x16x32_bf16 v[36:39], v[244:247], v[192:195], 0
    v_mfma_f32_16x16x32_bf16 v[40:43], v[244:247], v[196:199], 0
    ds_read_b128 v[208:211], v232 offset:26624
    ds_read_b128 v[212:215], v232 offset:27648
    ds_read_b64_tr_b16 v[244:245], v228 offset:0
    ds_read_b64_tr_b16 v[246:247], v228 offset:4096
    s_waitcnt lgkmcnt(14)
    v_mfma_f32_16x16x32_bf16 v[44:47], v[248:251], v[192:195], 0
    v_mfma_f32_16x16x32_bf16 v[48:51], v[248:251], v[196:199], 0
    ds_read_b64_tr_b16 v[248:249], v229 offset:0
    ds_read_b64_tr_b16 v[250:251], v229 offset:4096
    s_waitcnt lgkmcnt(14)
    v_mfma_f32_16x16x32_bf16 v[52:55], v[80:83], v[192:195], 0
    v_mfma_f32_16x16x32_bf16 v[56:59], v[80:83], v[196:199], 0
    ds_read_b64_tr_b16 v[80:81], v230 offset:0
    ds_read_b64_tr_b16 v[82:83], v230 offset:4096
    s_waitcnt lgkmcnt(14)
    v_mfma_f32_16x16x32_bf16 v[28:31], v[116:119], v[200:203], v[28:31]
    v_mfma_f32_16x16x32_bf16 v[32:35], v[116:119], v[204:207], v[32:35]
    ds_read_b64_tr_b16 v[116:117], v231 offset:0
    ds_read_b64_tr_b16 v[118:119], v231 offset:4096
    s_waitcnt lgkmcnt(14)
    v_mfma_f32_16x16x32_bf16 v[36:39], v[88:91], v[200:203], v[36:39]
    v_mfma_f32_16x16x32_bf16 v[40:43], v[88:91], v[204:207], v[40:43]
    ds_read_b128 v[216:219], v232 offset:28672
    ds_read_b128 v[220:223], v232 offset:29696
    ds_read_b64_tr_b16 v[88:89], v228 offset:32768
    ds_read_b64_tr_b16 v[90:91], v228 offset:36864
    s_waitcnt lgkmcnt(14)
    v_mfma_f32_16x16x32_bf16 v[44:47], v[124:127], v[200:203], v[44:47]
    v_mfma_f32_16x16x32_bf16 v[48:51], v[124:127], v[204:207], v[48:51]
    ds_read_b64_tr_b16 v[124:125], v229 offset:32768
    ds_read_b64_tr_b16 v[126:127], v229 offset:36864
    s_waitcnt lgkmcnt(14)
    v_mfma_f32_16x16x32_bf16 v[52:55], v[240:243], v[200:203], v[52:55]
    v_mfma_f32_16x16x32_bf16 v[56:59], v[240:243], v[204:207], v[56:59]
    ds_read_b64_tr_b16 v[240:241], v230 offset:32768
    ds_read_b64_tr_b16 v[242:243], v230 offset:36864
    s_waitcnt lgkmcnt(14)
    v_mfma_f32_16x16x32_bf16 v[28:31], v[244:247], v[208:211], v[28:31]
    v_mfma_f32_16x16x32_bf16 v[32:35], v[244:247], v[212:215], v[32:35]
    ds_read_b64_tr_b16 v[244:245], v231 offset:32768
    ds_read_b64_tr_b16 v[246:247], v231 offset:36864
    s_waitcnt lgkmcnt(14)
    v_mfma_f32_16x16x32_bf16 v[36:39], v[248:251], v[208:211], v[36:39]
    v_mfma_f32_16x16x32_bf16 v[40:43], v[248:251], v[212:215], v[40:43]
    s_waitcnt lgkmcnt(12)
    v_mfma_f32_16x16x32_bf16 v[44:47], v[80:83], v[208:211], v[44:47]
    v_mfma_f32_16x16x32_bf16 v[48:51], v[80:83], v[212:215], v[48:51]
    s_waitcnt lgkmcnt(10)
    v_mfma_f32_16x16x32_bf16 v[52:55], v[116:119], v[208:211], v[52:55]
    v_mfma_f32_16x16x32_bf16 v[56:59], v[116:119], v[212:215], v[56:59]
    s_waitcnt lgkmcnt(6)
    v_mfma_f32_16x16x32_bf16 v[28:31], v[88:91], v[216:219], v[28:31]
    v_mfma_f32_16x16x32_bf16 v[32:35], v[88:91], v[220:223], v[32:35]
    s_waitcnt lgkmcnt(4)
    v_mfma_f32_16x16x32_bf16 v[36:39], v[124:127], v[216:219], v[36:39]
    v_mfma_f32_16x16x32_bf16 v[40:43], v[124:127], v[220:223], v[40:43]
    s_waitcnt lgkmcnt(2)
    v_mfma_f32_16x16x32_bf16 v[44:47], v[240:243], v[216:219], v[44:47]
    v_mfma_f32_16x16x32_bf16 v[48:51], v[240:243], v[220:223], v[48:51]
    s_waitcnt lgkmcnt(0)
    s_barrier
    v_mfma_f32_16x16x32_bf16 v[52:55], v[244:247], v[216:219], v[52:55]
    v_mfma_f32_16x16x32_bf16 v[56:59], v[244:247], v[220:223], v[56:59]
    s_cmp_lt_u32 s3, 4
    s_cbranch_scc1 L_B_fx1
    s_mov_b32 vcc_lo, 0x55555555
    s_mov_b32 vcc_hi, 0x55555555
    s_waitcnt vmcnt(8)
    v_cndmask_b32_dpp v96, v132, v128, vcc quad_perm:[1,0,3,2] row_mask:0xf bank_mask:0xf
    v_cndmask_b32_dpp v97, v133, v129, vcc quad_perm:[1,0,3,2] row_mask:0xf bank_mask:0xf
    v_cndmask_b32_dpp v98, v134, v130, vcc quad_perm:[1,0,3,2] row_mask:0xf bank_mask:0xf
    v_cndmask_b32_dpp v99, v135, v131, vcc quad_perm:[1,0,3,2] row_mask:0xf bank_mask:0xf
    v_cndmask_b32_dpp v104, v140, v136, vcc quad_perm:[1,0,3,2] row_mask:0xf bank_mask:0xf
    v_cndmask_b32_dpp v105, v141, v137, vcc quad_perm:[1,0,3,2] row_mask:0xf bank_mask:0xf
    v_cndmask_b32_dpp v106, v142, v138, vcc quad_perm:[1,0,3,2] row_mask:0xf bank_mask:0xf
    v_cndmask_b32_dpp v107, v143, v139, vcc quad_perm:[1,0,3,2] row_mask:0xf bank_mask:0xf
    v_cndmask_b32_dpp v112, v148, v144, vcc quad_perm:[1,0,3,2] row_mask:0xf bank_mask:0xf
    v_cndmask_b32_dpp v113, v149, v145, vcc quad_perm:[1,0,3,2] row_mask:0xf bank_mask:0xf
    v_cndmask_b32_dpp v114, v150, v146, vcc quad_perm:[1,0,3,2] row_mask:0xf bank_mask:0xf
    v_cndmask_b32_dpp v115, v151, v147, vcc quad_perm:[1,0,3,2] row_mask:0xf bank_mask:0xf
    v_cndmask_b32_dpp v120, v156, v152, vcc quad_perm:[1,0,3,2] row_mask:0xf bank_mask:0xf
    v_cndmask_b32_dpp v121, v157, v153, vcc quad_perm:[1,0,3,2] row_mask:0xf bank_mask:0xf
    v_cndmask_b32_dpp v122, v158, v154, vcc quad_perm:[1,0,3,2] row_mask:0xf bank_mask:0xf
    v_cndmask_b32_dpp v123, v159, v155, vcc quad_perm:[1,0,3,2] row_mask:0xf bank_mask:0xf
    s_not_b64 vcc, vcc
    v_cndmask_b32_dpp v132, v128, v132, vcc quad_perm:[1,0,3,2] row_mask:0xf bank_mask:0xf
    v_cndmask_b32_dpp v133, v129, v133, vcc quad_perm:[1,0,3,2] row_mask:0xf bank_mask:0xf
    v_cndmask_b32_dpp v134, v130, v134, vcc quad_perm:[1,0,3,2] row_mask:0xf bank_mask:0xf
    v_cndmask_b32_dpp v135, v131, v135, vcc quad_perm:[1,0,3,2] row_mask:0xf bank_mask:0xf
    v_cndmask_b32_dpp v140, v136, v140, vcc quad_perm:[1,0,3,2] row_mask:0xf bank_mask:0xf
    v_cndmask_b32_dpp v141, v137, v141, vcc quad_perm:[1,0,3,2] row_mask:0xf bank_mask:0xf
    v_cndmask_b32_dpp v142, v138, v142, vcc quad_perm:[1,0,3,2] row_mask:0xf bank_mask:0xf
    v_cndmask_b32_dpp v143, v139, v143, vcc quad_perm:[1,0,3,2] row_mask:0xf bank_mask:0xf
    v_cndmask_b32_dpp v148, v144, v148, vcc quad_perm:[1,0,3,2] row_mask:0xf bank_mask:0xf
    v_cndmask_b32_dpp v149, v145, v149, vcc quad_perm:[1,0,3,2] row_mask:0xf bank_mask:0xf
    v_cndmask_b32_dpp v150, v146, v150, vcc quad_perm:[1,0,3,2] row_mask:0xf bank_mask:0xf
    v_cndmask_b32_dpp v151, v147, v151, vcc quad_perm:[1,0,3,2] row_mask:0xf bank_mask:0xf
    v_cndmask_b32_dpp v156, v152, v156, vcc quad_perm:[1,0,3,2] row_mask:0xf bank_mask:0xf
    v_cndmask_b32_dpp v157, v153, v157, vcc quad_perm:[1,0,3,2] row_mask:0xf bank_mask:0xf
    v_cndmask_b32_dpp v158, v154, v158, vcc quad_perm:[1,0,3,2] row_mask:0xf bank_mask:0xf
    v_cndmask_b32_dpp v159, v155, v159, vcc quad_perm:[1,0,3,2] row_mask:0xf bank_mask:0xf
    s_mov_b32 vcc_lo, 0x55555555
    s_mov_b32 vcc_hi, 0x55555555
    s_waitcnt vmcnt(0)
    v_cndmask_b32_dpp v128, v164, v160, vcc quad_perm:[1,0,3,2] row_mask:0xf bank_mask:0xf
    v_cndmask_b32_dpp v129, v165, v161, vcc quad_perm:[1,0,3,2] row_mask:0xf bank_mask:0xf
    v_cndmask_b32_dpp v130, v166, v162, vcc quad_perm:[1,0,3,2] row_mask:0xf bank_mask:0xf
    v_cndmask_b32_dpp v131, v167, v163, vcc quad_perm:[1,0,3,2] row_mask:0xf bank_mask:0xf
    v_cndmask_b32_dpp v136, v172, v168, vcc quad_perm:[1,0,3,2] row_mask:0xf bank_mask:0xf
    v_cndmask_b32_dpp v137, v173, v169, vcc quad_perm:[1,0,3,2] row_mask:0xf bank_mask:0xf
    v_cndmask_b32_dpp v138, v174, v170, vcc quad_perm:[1,0,3,2] row_mask:0xf bank_mask:0xf
    v_cndmask_b32_dpp v139, v175, v171, vcc quad_perm:[1,0,3,2] row_mask:0xf bank_mask:0xf
    v_cndmask_b32_dpp v144, v180, v176, vcc quad_perm:[1,0,3,2] row_mask:0xf bank_mask:0xf
    v_cndmask_b32_dpp v145, v181, v177, vcc quad_perm:[1,0,3,2] row_mask:0xf bank_mask:0xf
    v_cndmask_b32_dpp v146, v182, v178, vcc quad_perm:[1,0,3,2] row_mask:0xf bank_mask:0xf
    v_cndmask_b32_dpp v147, v183, v179, vcc quad_perm:[1,0,3,2] row_mask:0xf bank_mask:0xf
    v_cndmask_b32_dpp v152, v188, v184, vcc quad_perm:[1,0,3,2] row_mask:0xf bank_mask:0xf
    v_cndmask_b32_dpp v153, v189, v185, vcc quad_perm:[1,0,3,2] row_mask:0xf bank_mask:0xf
    v_cndmask_b32_dpp v154, v190, v186, vcc quad_perm:[1,0,3,2] row_mask:0xf bank_mask:0xf
    v_cndmask_b32_dpp v155, v191, v187, vcc quad_perm:[1,0,3,2] row_mask:0xf bank_mask:0xf
    s_not_b64 vcc, vcc
    v_cndmask_b32_dpp v164, v160, v164, vcc quad_perm:[1,0,3,2] row_mask:0xf bank_mask:0xf
    v_cndmask_b32_dpp v165, v161, v165, vcc quad_perm:[1,0,3,2] row_mask:0xf bank_mask:0xf
    v_cndmask_b32_dpp v166, v162, v166, vcc quad_perm:[1,0,3,2] row_mask:0xf bank_mask:0xf
    v_cndmask_b32_dpp v167, v163, v167, vcc quad_perm:[1,0,3,2] row_mask:0xf bank_mask:0xf
    v_cndmask_b32_dpp v172, v168, v172, vcc quad_perm:[1,0,3,2] row_mask:0xf bank_mask:0xf
    v_cndmask_b32_dpp v173, v169, v173, vcc quad_perm:[1,0,3,2] row_mask:0xf bank_mask:0xf
    v_cndmask_b32_dpp v174, v170, v174, vcc quad_perm:[1,0,3,2] row_mask:0xf bank_mask:0xf
    v_cndmask_b32_dpp v175, v171, v175, vcc quad_perm:[1,0,3,2] row_mask:0xf bank_mask:0xf
    v_cndmask_b32_dpp v180, v176, v180, vcc quad_perm:[1,0,3,2] row_mask:0xf bank_mask:0xf
    v_cndmask_b32_dpp v181, v177, v181, vcc quad_perm:[1,0,3,2] row_mask:0xf bank_mask:0xf
    v_cndmask_b32_dpp v182, v178, v182, vcc quad_perm:[1,0,3,2] row_mask:0xf bank_mask:0xf
    v_cndmask_b32_dpp v183, v179, v183, vcc quad_perm:[1,0,3,2] row_mask:0xf bank_mask:0xf
    v_cndmask_b32_dpp v188, v184, v188, vcc quad_perm:[1,0,3,2] row_mask:0xf bank_mask:0xf
    v_cndmask_b32_dpp v189, v185, v189, vcc quad_perm:[1,0,3,2] row_mask:0xf bank_mask:0xf
    v_cndmask_b32_dpp v190, v186, v190, vcc quad_perm:[1,0,3,2] row_mask:0xf bank_mask:0xf
    v_cndmask_b32_dpp v191, v187, v191, vcc quad_perm:[1,0,3,2] row_mask:0xf bank_mask:0xf
L_B_fx1:
    ds_read_b128 v[192:195], v6 offset:0
    ds_read_b128 v[196:199], v6 offset:1024
    ds_read_b128 v[200:203], v7 offset:2048
    ds_read_b128 v[204:207], v7 offset:3072
    ds_read_b128 v[208:211], v6 offset:4096
    ds_read_b128 v[212:215], v6 offset:5120
    ds_write_b128 v8, v[96:99] offset:0
    v_mfma_f32_16x16x32_bf16 v[12:15], v[172:175], v[60:63], 0
    v_mfma_f32_16x16x32_bf16 v[16:19], v[172:175], v[68:71], 0
    ds_write_b128 v9, v[132:135] offset:0
    v_mfma_f32_16x16x32_bf16 v[12:15], v[144:147], v[76:79], v[12:15]
    v_mfma_f32_16x16x32_bf16 v[16:19], v[144:147], v[84:87], v[16:19]
    ds_write_b128 v10, v[104:107] offset:0
    v_mfma_f32_16x16x32_bf16 v[12:15], v[180:183], v[92:95], v[12:15]
    v_mfma_f32_16x16x32_bf16 v[16:19], v[180:183], v[64:67], v[16:19]
    ds_write_b128 v11, v[140:143] offset:0
    v_mfma_f32_16x16x32_bf16 v[12:15], v[152:155], v[100:103], v[12:15]
    v_mfma_f32_16x16x32_bf16 v[16:19], v[152:155], v[72:75], v[16:19]
    ds_write_b128 v8, v[112:115] offset:256
    v_mfma_f32_16x16x32_bf16 v[12:15], v[188:191], v[108:111], v[12:15]
    v_mfma_f32_16x16x32_bf16 v[16:19], v[188:191], v[252:255], v[16:19]
    ds_read_b128 v[216:219], v7 offset:6144
    ds_read_b128 v[220:223], v7 offset:7168
    s_waitcnt lgkmcnt(11)
    ds_write_b128 v9, v[148:151] offset:256
    v_mfma_f32_16x16x32_bf16 v[12:15], v[96:99], v[192:195], v[12:15]
    v_mfma_f32_16x16x32_bf16 v[16:19], v[96:99], v[196:199], v[16:19]
    ds_read_b128 v[192:195], v6 offset:8192
    ds_read_b128 v[196:199], v6 offset:9216
    s_waitcnt lgkmcnt(12)
    ds_write_b128 v10, v[120:123] offset:256
    v_mfma_f32_16x16x32_bf16 v[12:15], v[132:135], v[200:203], v[12:15]
    v_mfma_f32_16x16x32_bf16 v[16:19], v[132:135], v[204:207], v[16:19]
    ds_read_b128 v[200:203], v7 offset:10240
    ds_read_b128 v[204:207], v7 offset:11264
    s_waitcnt lgkmcnt(13)
    ds_write_b128 v11, v[156:159] offset:256
    v_mfma_f32_16x16x32_bf16 v[12:15], v[104:107], v[208:211], v[12:15]
    v_mfma_f32_16x16x32_bf16 v[16:19], v[104:107], v[212:215], v[16:19]
    ds_read_b128 v[208:211], v6 offset:12288
    ds_read_b128 v[212:215], v6 offset:13312
    s_waitcnt lgkmcnt(9)
    ds_write_b128 v8, v[128:131] offset:512
    v_mfma_f32_16x16x32_bf16 v[12:15], v[140:143], v[216:219], v[12:15]
    v_mfma_f32_16x16x32_bf16 v[16:19], v[140:143], v[220:223], v[16:19]
    ds_read_b128 v[216:219], v7 offset:14336
    ds_read_b128 v[220:223], v7 offset:15360
    s_waitcnt lgkmcnt(9)
    ds_write_b128 v9, v[164:167] offset:512
    v_mfma_f32_16x16x32_bf16 v[12:15], v[112:115], v[192:195], v[12:15]
    v_mfma_f32_16x16x32_bf16 v[16:19], v[112:115], v[196:199], v[16:19]
    ds_read_b128 v[192:195], v6 offset:16384
    ds_read_b128 v[196:199], v6 offset:17408
    s_waitcnt lgkmcnt(9)
    ds_write_b128 v10, v[136:139] offset:512
    v_mfma_f32_16x16x32_bf16 v[12:15], v[148:151], v[200:203], v[12:15]
    v_mfma_f32_16x16x32_bf16 v[16:19], v[148:151], v[204:207], v[16:19]
    ds_read_b128 v[200:203], v7 offset:18432
    ds_read_b128 v[204:207], v7 offset:19456
    s_waitcnt lgkmcnt(9)
    ds_write_b128 v11, v[172:175] offset:512
    v_mfma_f32_16x16x32_bf16 v[12:15], v[120:123], v[208:211], v[12:15]
    v_mfma_f32_16x16x32_bf16 v[16:19], v[120:123], v[212:215], v[16:19]
    ds_read_b128 v[208:211], v6 offset:20480
    ds_read_b128 v[212:215], v6 offset:21504
    s_waitcnt lgkmcnt(9)
    ds_write_b128 v8, v[144:147] offset:768
    v_mfma_f32_16x16x32_bf16 v[12:15], v[156:159], v[216:219], v[12:15]
    v_mfma_f32_16x16x32_bf16 v[16:19], v[156:159], v[220:223], v[16:19]
    s_waitcnt lgkmcnt(7)
    ds_write_b128 v9, v[180:183] offset:768
    v_mfma_f32_16x16x32_bf16 v[12:15], v[128:131], v[192:195], v[12:15]
    v_mfma_f32_16x16x32_bf16 v[16:19], v[128:131], v[196:199], v[16:19]
    s_waitcnt lgkmcnt(5)
    ds_write_b128 v10, v[152:155] offset:768
    v_mfma_f32_16x16x32_bf16 v[12:15], v[164:167], v[200:203], v[12:15]
    v_mfma_f32_16x16x32_bf16 v[16:19], v[164:167], v[204:207], v[16:19]
    s_waitcnt lgkmcnt(3)
    ds_write_b128 v11, v[188:191] offset:768
    v_mfma_f32_16x16x32_bf16 v[12:15], v[136:139], v[208:211], v[12:15]
    v_mfma_f32_16x16x32_bf16 v[16:19], v[136:139], v[212:215], v[16:19]
    s_nop 6
    v_max3_f32 v4, v12, v13, v14
    v_max_f32 v4, v4, v15
    v_max3_f32 v5, v16, v17, v18
    v_max_f32 v5, v5, v19
    s_nop 1
    v_permlane16_swap_b32 v4, v5
    v_max_f32 v4, v4, v5
    v_mov_b32 v5, v4
    s_nop 1
    v_permlane32_swap_b32 v4, v5
    v_max_f32 v4, v4, v5
    ds_write_b32 v233, v4 offset:1024
    s_waitcnt lgkmcnt(0)
    s_barrier
    ds_read_b128 v[192:195], v234 offset:1024
    ds_read_b128 v[196:199], v234 offset:1040
    ds_read_b128 v[200:203], v234 offset:1536
    ds_read_b128 v[204:207], v234 offset:1552
    s_waitcnt lgkmcnt(2)
    v_max3_f32 v4, v192, v193, v194
    v_max3_f32 v5, v195, v196, v197
    v_max3_f32 v4, v4, v198, v199
    v_max3_f32 v4, v4, v5, v22
    v_mul_f32 v4, s10, v4
    v_sub_f32 v5, v24, v4
    v_mov_b32 v24, v4
    v_exp_f32 v240, v5
    v_exp_f32 v241, v5
    v_fma_f32 v12, v12, s10, -v24
    v_fma_f32 v13, v13, s10, -v24
    v_fma_f32 v14, v14, s10, -v24
    v_fma_f32 v15, v15, s10, -v24
    v_exp_f32 v12, v12
    v_exp_f32 v13, v13
    v_exp_f32 v14, v14
    v_exp_f32 v15, v15
    s_waitcnt lgkmcnt(0)
    v_max3_f32 v4, v200, v201, v202
    v_max3_f32 v5, v203, v204, v205
    v_max3_f32 v4, v4, v206, v207
    v_max3_f32 v4, v4, v5, v23
    v_mul_f32 v4, s10, v4
    v_sub_f32 v5, v25, v4
    v_mov_b32 v25, v4
    v_exp_f32 v242, v5
    v_exp_f32 v243, v5
    v_fma_f32 v16, v16, s10, -v25
    v_fma_f32 v17, v17, s10, -v25
    v_fma_f32 v18, v18, s10, -v25
    v_fma_f32 v19, v19, s10, -v25
    v_exp_f32 v16, v16
    v_exp_f32 v17, v17
    v_exp_f32 v18, v18
    v_exp_f32 v19, v19
    v_cvt_pk_bf16_f32 v192, v12, v13
    v_cvt_pk_bf16_f32 v193, v14, v15
    ds_write_b64 v235, v[192:193] offset:22528
    v_cvt_pk_bf16_f32 v194, v16, v17
    v_cvt_pk_bf16_f32 v195, v18, v19
    ds_write_b64 v235, v[194:195] offset:23552
    s_waitcnt lgkmcnt(0)
    s_barrier
    ds_read_b128 v[192:195], v232 offset:22528
    ds_read_b128 v[196:199], v232 offset:23552
    ds_read_b64_tr_b16 v[96:97], v224 offset:0
    ds_read_b64_tr_b16 v[98:99], v224 offset:4096
    ds_read_b64_tr_b16 v[100:101], v225 offset:0
    ds_read_b64_tr_b16 v[102:103], v225 offset:4096
    ds_read_b64_tr_b16 v[104:105], v226 offset:0
    ds_read_b64_tr_b16 v[106:107], v226 offset:4096
    ds_read_b64_tr_b16 v[108:109], v227 offset:0
    ds_read_b64_tr_b16 v[110:111], v227 offset:4096
    ds_read_b128 v[200:203], v232 offset:24576
    ds_read_b128 v[204:207], v232 offset:25600
    ds_read_b64_tr_b16 v[112:113], v224 offset:32768
    ds_read_b64_tr_b16 v[114:115], v224 offset:36864
    ds_read_b64_tr_b16 v[116:117], v225 offset:32768
    ds_read_b64_tr_b16 v[118:119], v225 offset:36864
    v_add_f32 v12, v12, v13
    v_add_f32 v14, v14, v15
    v_add_f32 v12, v12, v14
    v_fma_f32 v4, v20, v240, v12
    v_add_f32 v16, v16, v17
    v_add_f32 v18, v18, v19
    v_add_f32 v16, v16, v18
    v_fma_f32 v5, v21, v242, v16
    v_pk_mul_f32 v[28:29], v[28:29], v[240:241]
    v_pk_mul_f32 v[30:31], v[30:31], v[240:241]
    v_pk_mul_f32 v[32:33], v[32:33], v[242:243]
    v_pk_mul_f32 v[34:35], v[34:35], v[242:243]
    v_pk_mul_f32 v[36:37], v[36:37], v[240:241]
    v_pk_mul_f32 v[38:39], v[38:39], v[240:241]
    v_pk_mul_f32 v[40:41], v[40:41], v[242:243]
    v_pk_mul_f32 v[42:43], v[42:43], v[242:243]
    v_pk_mul_f32 v[44:45], v[44:45], v[240:241]
    v_pk_mul_f32 v[46:47], v[46:47], v[240:241]
    v_pk_mul_f32 v[48:49], v[48:49], v[242:243]
    v_pk_mul_f32 v[50:51], v[50:51], v[242:243]
    v_pk_mul_f32 v[52:53], v[52:53], v[240:241]
    v_pk_mul_f32 v[54:55], v[54:55], v[240:241]
    v_pk_mul_f32 v[56:57], v[56:57], v[242:243]
    v_pk_mul_f32 v[58:59], v[58:59], v[242:243]
    ds_read_b64_tr_b16 v[120:121], v226 offset:32768
    ds_read_b64_tr_b16 v[122:123], v226 offset:36864
    s_waitcnt lgkmcnt(14)
    v_mfma_f32_16x16x32_bf16 v[28:31], v[96:99], v[192:195], v[28:31]
    v_mfma_f32_16x16x32_bf16 v[32:35], v[96:99], v[196:199], v[32:35]
    ds_read_b64_tr_b16 v[96:97], v227 offset:32768
    ds_read_b64_tr_b16 v[98:99], v227 offset:36864
    s_waitcnt lgkmcnt(14)
    v_mfma_f32_16x16x32_bf16 v[36:39], v[100:103], v[192:195], v[36:39]
    v_mfma_f32_16x16x32_bf16 v[40:43], v[100:103], v[196:199], v[40:43]
    ds_read_b128 v[208:211], v232 offset:26624
    ds_read_b128 v[212:215], v232 offset:27648
    ds_read_b64_tr_b16 v[100:101], v228 offset:0
    ds_read_b64_tr_b16 v[102:103], v228 offset:4096
    v_permlane16_swap_b32 v4, v5
    v_add_f32 v4, v4, v5
    v_mov_b32 v5, v4
    s_nop 1
    v_permlane32_swap_b32 v4, v5
    v_add_f32 v4, v4, v5
    ds_write_b32 v233, v4
    s_waitcnt lgkmcnt(14)
    v_mfma_f32_16x16x32_bf16 v[44:47], v[104:107], v[192:195], v[44:47]
    v_mfma_f32_16x16x32_bf16 v[48:51], v[104:107], v[196:199], v[48:51]
    ds_read_b64_tr_b16 v[104:105], v229 offset:0
    ds_read_b64_tr_b16 v[106:107], v229 offset:4096
    s_waitcnt lgkmcnt(14)
    v_mfma_f32_16x16x32_bf16 v[52:55], v[108:111], v[192:195], v[52:55]
    v_mfma_f32_16x16x32_bf16 v[56:59], v[108:111], v[196:199], v[56:59]
    ds_read_b64_tr_b16 v[108:109], v230 offset:0
    ds_read_b64_tr_b16 v[110:111], v230 offset:4096
    s_waitcnt lgkmcnt(14)
    v_mfma_f32_16x16x32_bf16 v[28:31], v[112:115], v[200:203], v[28:31]
    v_mfma_f32_16x16x32_bf16 v[32:35], v[112:115], v[204:207], v[32:35]
    ds_read_b64_tr_b16 v[112:113], v231 offset:0
    ds_read_b64_tr_b16 v[114:115], v231 offset:4096
    s_waitcnt lgkmcnt(14)
    v_mfma_f32_16x16x32_bf16 v[36:39], v[116:119], v[200:203], v[36:39]
    v_mfma_f32_16x16x32_bf16 v[40:43], v[116:119], v[204:207], v[40:43]
    ds_read_b128 v[216:219], v232 offset:28672
    ds_read_b128 v[220:223], v232 offset:29696
    ds_read_b64_tr_b16 v[116:117], v228 offset:32768
    ds_read_b64_tr_b16 v[118:119], v228 offset:36864
    s_waitcnt lgkmcnt(14)
    v_mfma_f32_16x16x32_bf16 v[44:47], v[120:123], v[200:203], v[44:47]
    v_mfma_f32_16x16x32_bf16 v[48:51], v[120:123], v[204:207], v[48:51]
    ds_read_b64_tr_b16 v[120:121], v229 offset:32768
    ds_read_b64_tr_b16 v[122:123], v229 offset:36864
    s_waitcnt lgkmcnt(14)
    v_mfma_f32_16x16x32_bf16 v[52:55], v[96:99], v[200:203], v[52:55]
    v_mfma_f32_16x16x32_bf16 v[56:59], v[96:99], v[204:207], v[56:59]
    ds_read_b64_tr_b16 v[96:97], v230 offset:32768
    ds_read_b64_tr_b16 v[98:99], v230 offset:36864
    s_waitcnt lgkmcnt(14)
    v_mfma_f32_16x16x32_bf16 v[28:31], v[100:103], v[208:211], v[28:31]
    v_mfma_f32_16x16x32_bf16 v[32:35], v[100:103], v[212:215], v[32:35]
    ds_read_b64_tr_b16 v[100:101], v231 offset:32768
    ds_read_b64_tr_b16 v[102:103], v231 offset:36864
    s_waitcnt lgkmcnt(14)
    v_mfma_f32_16x16x32_bf16 v[36:39], v[104:107], v[208:211], v[36:39]
    v_mfma_f32_16x16x32_bf16 v[40:43], v[104:107], v[212:215], v[40:43]
    s_waitcnt lgkmcnt(12)
    v_mfma_f32_16x16x32_bf16 v[44:47], v[108:111], v[208:211], v[44:47]
    v_mfma_f32_16x16x32_bf16 v[48:51], v[108:111], v[212:215], v[48:51]
    s_waitcnt lgkmcnt(10)
    v_mfma_f32_16x16x32_bf16 v[52:55], v[112:115], v[208:211], v[52:55]
    v_mfma_f32_16x16x32_bf16 v[56:59], v[112:115], v[212:215], v[56:59]
    s_waitcnt lgkmcnt(6)
    v_mfma_f32_16x16x32_bf16 v[28:31], v[116:119], v[216:219], v[28:31]
    v_mfma_f32_16x16x32_bf16 v[32:35], v[116:119], v[220:223], v[32:35]
    s_waitcnt lgkmcnt(4)
    v_mfma_f32_16x16x32_bf16 v[36:39], v[120:123], v[216:219], v[36:39]
    v_mfma_f32_16x16x32_bf16 v[40:43], v[120:123], v[220:223], v[40:43]
    s_waitcnt lgkmcnt(2)
    v_mfma_f32_16x16x32_bf16 v[44:47], v[96:99], v[216:219], v[44:47]
    v_mfma_f32_16x16x32_bf16 v[48:51], v[96:99], v[220:223], v[48:51]
    s_waitcnt lgkmcnt(0)
    s_barrier
    ds_read_b128 v[64:67], v234 offset:0
    ds_read_b128 v[68:71], v234 offset:16
    ds_read_b128 v[72:75], v234 offset:512
    ds_read_b128 v[76:79], v234 offset:528
    v_mfma_f32_16x16x32_bf16 v[52:55], v[100:103], v[216:219], v[52:55]
    v_mfma_f32_16x16x32_bf16 v[56:59], v[100:103], v[220:223], v[56:59]
    s_waitcnt lgkmcnt(0)
    v_add_f32 v64, v64, v65
    v_add_f32 v66, v66, v67
    v_add_f32 v68, v68, v69
    v_add_f32 v70, v70, v71
    v_add_f32 v64, v64, v66
    v_add_f32 v68, v68, v70
    v_add_f32 v64, v64, v68
    v_rcp_f32 v80, v64
    v_rcp_f32 v81, v64
    v_add_f32 v72, v72, v73
    v_add_f32 v74, v74, v75
    v_add_f32 v76, v76, v77
    v_add_f32 v78, v78, v79
    v_add_f32 v72, v72, v74
    v_add_f32 v76, v76, v78
    v_add_f32 v72, v72, v76
    v_rcp_f32 v82, v72
    v_rcp_f32 v83, v72
    v_pk_mul_f32 v[28:29], v[28:29], v[80:81]
    v_pk_mul_f32 v[30:31], v[30:31], v[80:81]
    v_cvt_pk_bf16_f32 v144, v28, v29
    v_cvt_pk_bf16_f32 v145, v30, v31
    ds_write_b64 v236, v[144:145] offset:0
    v_pk_mul_f32 v[32:33], v[32:33], v[82:83]
    v_pk_mul_f32 v[34:35], v[34:35], v[82:83]
    v_cvt_pk_bf16_f32 v146, v32, v33
    v_cvt_pk_bf16_f32 v147, v34, v35
    ds_write_b64 v236, v[146:147] offset:2304
    v_pk_mul_f32 v[36:37], v[36:37], v[80:81]
    v_pk_mul_f32 v[38:39], v[38:39], v[80:81]
    v_cvt_pk_bf16_f32 v148, v36, v37
    v_cvt_pk_bf16_f32 v149, v38, v39
    ds_write_b64 v236, v[148:149] offset:32
    v_pk_mul_f32 v[40:41], v[40:41], v[82:83]
    v_pk_mul_f32 v[42:43], v[42:43], v[82:83]
    v_cvt_pk_bf16_f32 v150, v40, v41
    v_cvt_pk_bf16_f32 v151, v42, v43
    ds_write_b64 v236, v[150:151] offset:2336
    v_pk_mul_f32 v[44:45], v[44:45], v[80:81]
    v_pk_mul_f32 v[46:47], v[46:47], v[80:81]
    v_cvt_pk_bf16_f32 v152, v44, v45
    v_cvt_pk_bf16_f32 v153, v46, v47
    ds_write_b64 v236, v[152:153] offset:64
    v_pk_mul_f32 v[48:49], v[48:49], v[82:83]
    v_pk_mul_f32 v[50:51], v[50:51], v[82:83]
    v_cvt_pk_bf16_f32 v154, v48, v49
    v_cvt_pk_bf16_f32 v155, v50, v51
    ds_write_b64 v236, v[154:155] offset:2368
    v_pk_mul_f32 v[52:53], v[52:53], v[80:81]
    v_pk_mul_f32 v[54:55], v[54:55], v[80:81]
    v_cvt_pk_bf16_f32 v156, v52, v53
    v_cvt_pk_bf16_f32 v157, v54, v55
    ds_write_b64 v236, v[156:157] offset:96
    v_pk_mul_f32 v[56:57], v[56:57], v[82:83]
    v_pk_mul_f32 v[58:59], v[58:59], v[82:83]
    v_cvt_pk_bf16_f32 v158, v56, v57
    v_cvt_pk_bf16_f32 v159, v58, v59
    ds_write_b64 v236, v[158:159] offset:2400
    ds_read_b128 v[160:163], v237 offset:0
    ds_read_b128 v[164:167], v237 offset:1152
    ds_read_b128 v[168:171], v237 offset:2304
    ds_read_b128 v[172:175], v237 offset:3456
    s_waitcnt lgkmcnt(3)
    buffer_store_dwordx4 v[160:163], v238, s[44:47], s74 offen sc1
    s_add_u32 s74, s74, 262144
    s_waitcnt lgkmcnt(2)
    buffer_store_dwordx4 v[164:167], v238, s[44:47], s74 offen sc1
    s_add_u32 s74, s74, 262144
    s_waitcnt lgkmcnt(1)
    buffer_store_dwordx4 v[168:171], v238, s[44:47], s74 offen sc1
    s_add_u32 s74, s74, 262144
    s_waitcnt lgkmcnt(0)
    buffer_store_dwordx4 v[172:175], v238, s[44:47], s74 offen sc1
    v_log_f32 v4, v64
    v_log_f32 v5, v72
    v_mov_b32 v11, s4
    v_add_f32 v4, v4, v24
    v_add_f32 v5, v5, v25
    v_cndmask_b32 v10, v4, v5, s[12:13]
    s_mov_b32 s64, s24
    s_and_b32 s65, s25, 0xffff
    s_mov_b32 s66, 4194304
    s_mov_b32 s67, 0x00020000
    v_lshlrev_b32 v12, 11, v1
    v_lshl_add_u32 v12, v2, 4, v12
    s_and_b32 s75, s3, 3
    s_lshl_b32 s76, s71, 16
    s_lshl_b32 s80, s75, 8
    s_add_u32 s76, s76, s80
    s_lshr_b32 s7, s71, 2
    s_lshl_b32 s7, s7, 8
    s_add_u32 s7, s7, 4096
    s_add_u32 s98, s42, s7
    s_addc_u32 s99, s43, 0
    s_mov_b32 s11, 20000
    s_mov_b32 s100, s4
    s_cmp_lg_u32 s3, 1
    s_cbranch_scc1 L_T1_np
    s_load_dword s100, s[98:99], 128 glc
L_T1_np:
    s_waitcnt vmcnt(0)
    s_barrier
    s_cmp_lg_u32 s3, 0
    s_cbranch_scc1 L_B_done
    s_mov_b32 exec_hi, 0
    buffer_store_dwordx2 v[10:11], v239, s[44:47], s77 offen sc1
    s_mov_b64 exec, -1
L_B_done:
    s_cmp_ge_u32 s3, 4
    s_cbranch_scc1 L_B_end
L_T1_w:
    s_waitcnt lgkmcnt(0)
    s_cmp_eq_u32 s100, s4
    s_cbranch_scc1 L_T1_wd
    s_sleep 2
    s_load_dword s100, s[98:99], 128 glc
    s_sub_u32 s11, s11, 1
    s_cmp_gt_i32 s11, 0
    s_cbranch_scc1 L_T1_w
    s_waitcnt lgkmcnt(0)
L_T1_wd:
    s_barrier
    buffer_load_dwordx4 v[64:67], v12, s[64:67], s76 offen offset:0 nt
    buffer_load_dwordx4 v[80:83], v12, s[64:67], s76 offen offset:1024 nt
    s_add_u32 s76, s76, 8192
    buffer_load_dwordx4 v[68:71], v12, s[64:67], s76 offen offset:0 nt
    buffer_load_dwordx4 v[84:87], v12, s[64:67], s76 offen offset:1024 nt
    s_add_u32 s76, s76, 8192
    buffer_load_dwordx4 v[72:75], v12, s[64:67], s76 offen offset:0 nt
    buffer_load_dwordx4 v[88:91], v12, s[64:67], s76 offen offset:1024 nt
    s_add_u32 s76, s76, 8192
    buffer_load_dwordx4 v[76:79], v12, s[64:67], s76 offen offset:0 nt
    buffer_load_dwordx4 v[92:95], v12, s[64:67], s76 offen offset:1024 nt
    s_add_u32 s76, s76, 8192
    buffer_load_dwordx4 v[96:99], v12, s[64:67], s76 offen offset:0 nt
    buffer_load_dwordx4 v[112:115], v12, s[64:67], s76 offen offset:1024 nt
    s_add_u32 s76, s76, 8192
    buffer_load_dwordx4 v[100:103], v12, s[64:67], s76 offen offset:0 nt
    buffer_load_dwordx4 v[116:119], v12, s[64:67], s76 offen offset:1024 nt
    s_add_u32 s76, s76, 8192
    buffer_load_dwordx4 v[104:107], v12, s[64:67], s76 offen offset:0 nt
    buffer_load_dwordx4 v[120:123], v12, s[64:67], s76 offen offset:1024 nt
    s_add_u32 s76, s76, 8192
    buffer_load_dwordx4 v[108:111], v12, s[64:67], s76 offen offset:0 nt
    buffer_load_dwordx4 v[124:127], v12, s[64:67], s76 offen offset:1024 nt
    s_branch L_T1
L_B_end:
    s_endpgm
L_H:
    s_and_b32 s68, s2, 31
    s_cmp_lt_u32 s2, 160
    s_cselect_b32 s69, 1, 0
    v_lshl_add_u32 v5, v15, 13, v13
    s_lshl_b32 s5, s69, 3
    s_add_u32 s5, s5, s3
    s_lshl_b32 s76, s5, 18
    s_lshl_b32 s6, s68, 8
    s_add_u32 s76, s76, s6
    s_waitcnt lgkmcnt(0)
    s_mov_b32 s56, s32
    s_and_b32 s57, s33, 0xffff
    s_mov_b32 s58, 4194304
    s_mov_b32 s59, 0x00020000
    s_add_u32 s5, s76, 0
    buffer_load_dwordx4 v[64:67], v5, s[56:59], s5 offen offset:0 nt
    buffer_load_dwordx4 v[68:71], v5, s[56:59], s5 offen offset:128 nt
    s_add_u32 s5, s76, 16384
    buffer_load_dwordx4 v[72:75], v5, s[56:59], s5 offen offset:0 nt
    buffer_load_dwordx4 v[76:79], v5, s[56:59], s5 offen offset:128 nt
    s_add_u32 s5, s76, 32768
    buffer_load_dwordx4 v[80:83], v5, s[56:59], s5 offen offset:0 nt
    buffer_load_dwordx4 v[84:87], v5, s[56:59], s5 offen offset:128 nt
    s_add_u32 s5, s76, 49152
    buffer_load_dwordx4 v[88:91], v5, s[56:59], s5 offen offset:0 nt
    buffer_load_dwordx4 v[92:95], v5, s[56:59], s5 offen offset:128 nt
    s_mov_b32 s60, s34
    s_and_b32 s61, s35, 0xffff
    s_mov_b32 s62, 4194304
    s_mov_b32 s63, 0x00020000
    s_lshl_b32 s72, s3, 19
    s_lshl_b32 s6, s68, 8
    s_add_u32 s72, s72, s6
    v_lshlrev_b32 v3, 16, v1
    v_lshl_add_u32 v3, v2, 4, v3
    s_mov_b32 s64, s28
    s_and_b32 s65, s29, 0xffff
    s_mov_b32 s66, 16777216
    s_mov_b32 s67, 0x00020000
    s_xor_b32 s5, s69, 1
    s_lshl_b32 s5, s5, 5
    s_add_u32 s5, s5, s68
    s_lshl_b32 s5, s5, 18
    s_lshl_b32 s6, s3, 14
    s_add_u32 s5, s5, s6
    s_add_u32 s5, s5, 135168
    s_add_u32 s6, s5, 8192
    v_lshlrev_b32 v7, 4, v0
    s_barrier
    buffer_load_dwordx4 v[160:163], v7, s[64:67], s5 offen offset:0
    buffer_load_dwordx4 v[164:167], v7, s[64:67], s5 offen offset:1024
    buffer_load_dwordx4 v[168:171], v7, s[64:67], s5 offen offset:2048
    buffer_load_dwordx4 v[172:175], v7, s[64:67], s5 offen offset:3072
    buffer_load_dwordx4 v[176:179], v7, s[64:67], s6 offen offset:0
    buffer_load_dwordx4 v[180:183], v7, s[64:67], s6 offen offset:1024
    s_load_dword s4, s[42:43], 0
    s_mov_b32 s44, s42
    s_and_b32 s45, s43, 0xffff
    s_mov_b32 s46, 4718592
    s_mov_b32 s47, 0x00020000
    v_lshlrev_b32 v7, 4, v0
    s_lshl_b32 s5, s68, 13
    s_lshl_b32 s6, s3, 10
    s_add_u32 s5, s5, s6
    s_add_u32 s5, s5, 786432
    v_lshlrev_b32 v4, 5, v2
    v_lshl_add_u32 v4, v1, 3, v4
    s_lshl_b32 s6, s3, 9
    v_add_u32 v4, s6, v4
    v_and_b32 v8, 3, v2
    v_lshrrev_b32 v9, 3, v2
    v_lshl_add_u32 v8, v9, 2, v8
    v_lshlrev_b32 v9, 9, v8
    v_bfe_u32 v8, v2, 2, 1
    v_lshl_add_u32 v9, v8, 5, v9
    v_lshl_add_u32 v9, v1, 6, v9
    v_lshlrev_b32 v10, 9, v2
    v_lshl_add_u32 v10, v1, 4, v10
    s_lshl_b32 s6, s3, 6
    v_add_u32 v10, s6, v10
    v_lshrrev_b32 v6, 5, v0
    v_lshlrev_b32 v6, 15, v6
    v_and_b32 v8, 31, v0
    v_lshl_add_u32 v6, v8, 4, v6
    s_lshl_b32 s77, s68, 10
    s_lshl_b32 s6, s69, 9
    s_add_u32 s77, s77, s6
    s_add_u32 s77, s77, 65536
    s_lshl_b32 s76, s69, 5
    s_add_u32 s76, s76, s68
    s_lshl_b32 s76, s76, 2
    s_add_u32 s76, s76, 16384
    s_waitcnt lgkmcnt(0)
    s_mul_i32 s4, s4, 0x9E3779B1
    s_add_u32 s4, s4, 0x7F4A7C15
    s_mov_b32 s11, 20000
L_H_real:
    s_waitcnt vmcnt(0)
L_H_p1:
    buffer_load_dwordx4 v[16:19], v7, s[44:47], s5 offen sc1
    s_waitcnt vmcnt(0)
    v_xor_b32 v11, s4, v17
    v_bitop3_b32 v11, v11, v19, s4 bitop3:0xf6
    v_cmp_ne_u32 vcc, 0, v11
    s_cbranch_vccz L_H_p1d
    s_sleep 3
    s_sub_u32 s11, s11, 1
    s_cmp_gt_i32 s11, 0
    s_cbranch_scc1 L_H_p1
L_H_p1d:
    v_mov_b32 v17, v18
    ds_write_b64 v4, v[16:17] offset:32768
    s_waitcnt lgkmcnt(0)
    s_barrier
    ds_read_b128 v[32:35], v9 offset:32768
    ds_read_b128 v[36:39], v9 offset:32784
    ds_read_b128 v[40:43], v9 offset:33024
    ds_read_b128 v[44:47], v9 offset:33040
    s_waitcnt lgkmcnt(0)
    v_add_f32_dpp v32, v32, v32 quad_perm:[2,3,0,1] row_mask:0xf bank_mask:0xf
    v_add_f32_dpp v33, v33, v33 quad_perm:[2,3,0,1] row_mask:0xf bank_mask:0xf
    v_add_f32_dpp v34, v34, v34 quad_perm:[2,3,0,1] row_mask:0xf bank_mask:0xf
    v_add_f32_dpp v35, v35, v35 quad_perm:[2,3,0,1] row_mask:0xf bank_mask:0xf
    v_add_f32_dpp v36, v36, v36 quad_perm:[2,3,0,1] row_mask:0xf bank_mask:0xf
    v_add_f32_dpp v37, v37, v37 quad_perm:[2,3,0,1] row_mask:0xf bank_mask:0xf
    v_add_f32_dpp v38, v38, v38 quad_perm:[2,3,0,1] row_mask:0xf bank_mask:0xf
    v_add_f32_dpp v39, v39, v39 quad_perm:[2,3,0,1] row_mask:0xf bank_mask:0xf
    v_add_f32_dpp v40, v40, v40 quad_perm:[2,3,0,1] row_mask:0xf bank_mask:0xf
    v_add_f32_dpp v41, v41, v41 quad_perm:[2,3,0,1] row_mask:0xf bank_mask:0xf
    v_add_f32_dpp v42, v42, v42 quad_perm:[2,3,0,1] row_mask:0xf bank_mask:0xf
    v_add_f32_dpp v43, v43, v43 quad_perm:[2,3,0,1] row_mask:0xf bank_mask:0xf
    v_add_f32_dpp v44, v44, v44 quad_perm:[2,3,0,1] row_mask:0xf bank_mask:0xf
    v_add_f32_dpp v45, v45, v45 quad_perm:[2,3,0,1] row_mask:0xf bank_mask:0xf
    v_add_f32_dpp v46, v46, v46 quad_perm:[2,3,0,1] row_mask:0xf bank_mask:0xf
    v_add_f32_dpp v47, v47, v47 quad_perm:[2,3,0,1] row_mask:0xf bank_mask:0xf
    v_add_f32_dpp v32, v32, v32 row_ror:8 row_mask:0xf bank_mask:0xf
    v_add_f32_dpp v33, v33, v33 row_ror:8 row_mask:0xf bank_mask:0xf
    v_add_f32_dpp v34, v34, v34 row_ror:8 row_mask:0xf bank_mask:0xf
    v_add_f32_dpp v35, v35, v35 row_ror:8 row_mask:0xf bank_mask:0xf
    v_add_f32_dpp v36, v36, v36 row_ror:8 row_mask:0xf bank_mask:0xf
    v_add_f32_dpp v37, v37, v37 row_ror:8 row_mask:0xf bank_mask:0xf
    v_add_f32_dpp v38, v38, v38 row_ror:8 row_mask:0xf bank_mask:0xf
    v_add_f32_dpp v39, v39, v39 row_ror:8 row_mask:0xf bank_mask:0xf
    v_add_f32_dpp v40, v40, v40 row_ror:8 row_mask:0xf bank_mask:0xf
    v_add_f32_dpp v41, v41, v41 row_ror:8 row_mask:0xf bank_mask:0xf
    v_add_f32_dpp v42, v42, v42 row_ror:8 row_mask:0xf bank_mask:0xf
    v_add_f32_dpp v43, v43, v43 row_ror:8 row_mask:0xf bank_mask:0xf
    v_add_f32_dpp v44, v44, v44 row_ror:8 row_mask:0xf bank_mask:0xf
    v_add_f32_dpp v45, v45, v45 row_ror:8 row_mask:0xf bank_mask:0xf
    v_add_f32_dpp v46, v46, v46 row_ror:8 row_mask:0xf bank_mask:0xf
    v_add_f32_dpp v47, v47, v47 row_ror:8 row_mask:0xf bank_mask:0xf
    v_cvt_pk_bf16_f32 v24, v32, v33
    v_cvt_pk_bf16_f32 v25, v34, v35
    v_cvt_pk_bf16_f32 v26, v36, v37
    v_cvt_pk_bf16_f32 v27, v38, v39
    v_cvt_pk_bf16_f32 v28, v40, v41
    v_cvt_pk_bf16_f32 v29, v42, v43
    v_cvt_pk_bf16_f32 v30, v44, v45
    v_cvt_pk_bf16_f32 v31, v46, v47
    v_mfma_f32_16x16x32_bf16 v[192:195], v[64:67], v[24:27], 0
    v_mfma_f32_16x16x32_bf16 v[196:199], v[72:75], v[24:27], 0
    v_mfma_f32_16x16x32_bf16 v[200:203], v[80:83], v[24:27], 0
    v_mfma_f32_16x16x32_bf16 v[204:207], v[88:91], v[24:27], 0
    v_mfma_f32_16x16x32_bf16 v[192:195], v[68:71], v[28:31], v[192:195]
    v_mfma_f32_16x16x32_bf16 v[196:199], v[76:79], v[28:31], v[196:199]
    v_mfma_f32_16x16x32_bf16 v[200:203], v[84:87], v[28:31], v[200:203]
    v_mfma_f32_16x16x32_bf16 v[204:207], v[92:95], v[28:31], v[204:207]
    s_nop 4
    v_add_f32_dpp v32, v193, v192 row_ror:4 row_mask:0xf bank_mask:0xf
    v_add_f32_dpp v33, v195, v194 row_ror:4 row_mask:0xf bank_mask:0xf
    v_add_f32_dpp v34, v197, v196 row_ror:4 row_mask:0xf bank_mask:0xf
    v_add_f32_dpp v35, v199, v198 row_ror:4 row_mask:0xf bank_mask:0xf
    v_add_f32_dpp v36, v201, v200 row_ror:4 row_mask:0xf bank_mask:0xf
    v_add_f32_dpp v37, v203, v202 row_ror:4 row_mask:0xf bank_mask:0xf
    v_add_f32_dpp v38, v205, v204 row_ror:4 row_mask:0xf bank_mask:0xf
    v_add_f32_dpp v39, v207, v206 row_ror:4 row_mask:0xf bank_mask:0xf
    v_cvt_pk_bf16_f32 v48, v32, v33
    v_cvt_pk_bf16_f32 v49, v34, v35
    v_cvt_pk_bf16_f32 v50, v36, v37
    v_cvt_pk_bf16_f32 v51, v38, v39
    s_mov_b32 exec_lo, 0x00030003
    s_mov_b32 exec_hi, 0x00030003
    ds_write_b128 v10, v[48:51] offset:36864
    s_mov_b64 exec, -1
    s_waitcnt lgkmcnt(0)
    s_barrier
    s_cmp_lg_u32 s3, 0
    s_cbranch_scc1 L_H_nof2
    ds_read_b128 v[48:51], v7 offset:36864
    v_lshlrev_b32 v9, 8, v0
    v_mov_b32 v8, s4
    s_waitcnt lgkmcnt(0)
    buffer_store_dwordx4 v[48:51], v6, s[44:47], s77 offen sc1
    s_waitcnt vmcnt(0)
    s_mov_b32 exec_hi, 0
    s_mov_b32 exec_lo, 0xff
    buffer_store_dword v8, v9, s[44:47], s76 offen sc1
    s_mov_b64 exec, -1
L_H_nof2:
    s_cmp_lt_u32 s2, 160
    s_cbranch_scc1 L_A
    s_barrier
    s_lshr_b32 s5, s3, 2
    s_lshl_b32 s71, s68, 1
    s_add_u32 s71, s71, s5
    s_lshl_b32 s73, s3, 7
    s_mov_b32 s78, 0xff00ff00
    s_mov_b32 s79, 0xff00ff00
    s_mov_b32 s64, s36
    s_and_b32 s65, s37, 0xffff
    s_mov_b32 s66, 4194304
    s_mov_b32 s67, 0x00020000
    s_add_u32 s5, s72, 0
    buffer_load_dwordx4 v[128:131], v3, s[60:63], s5 offen nt
    s_add_u32 s5, s72, 8192
    buffer_load_dwordx4 v[132:135], v3, s[60:63], s5 offen nt
    s_add_u32 s5, s72, 16384
    buffer_load_dwordx4 v[136:139], v3, s[60:63], s5 offen nt
    s_add_u32 s5, s72, 24576
    buffer_load_dwordx4 v[140:143], v3, s[60:63], s5 offen nt
    s_add_u32 s5, s72, 32768
    s_waitcnt vmcnt(3)
    buffer_load_dwordx4 v[144:147], v3, s[60:63], s5 offen nt
    s_add_u32 s5, s72, 40960
    s_waitcnt vmcnt(3)
    buffer_load_dwordx4 v[148:151], v3, s[60:63], s5 offen nt
    s_add_u32 s5, s72, 49152
    s_waitcnt vmcnt(3)
    buffer_load_dwordx4 v[152:155], v3, s[60:63], s5 offen nt
    s_add_u32 s5, s72, 57344
    s_waitcnt vmcnt(3)
    buffer_load_dwordx4 v[156:159], v3, s[60:63], s5 offen nt
    s_add_u32 s5, s72, 262144
    s_waitcnt vmcnt(3)
    buffer_load_dwordx4 v[224:227], v3, s[60:63], s5 offen nt
    s_add_u32 s5, s72, 270336
    s_waitcnt vmcnt(3)
    buffer_load_dwordx4 v[228:231], v3, s[60:63], s5 offen nt
    s_add_u32 s5, s72, 278528
    s_waitcnt vmcnt(3)
    buffer_load_dwordx4 v[232:235], v3, s[60:63], s5 offen nt
    s_add_u32 s5, s72, 286720
    s_waitcnt vmcnt(3)
    buffer_load_dwordx4 v[236:239], v3, s[60:63], s5 offen nt
    s_add_u32 s5, s72, 294912
    s_waitcnt vmcnt(3)
    buffer_load_dwordx4 v[240:243], v3, s[60:63], s5 offen nt
    s_add_u32 s5, s72, 303104
    s_waitcnt vmcnt(3)
    buffer_load_dwordx4 v[244:247], v3, s[60:63], s5 offen nt
    s_add_u32 s5, s72, 311296
    s_waitcnt vmcnt(3)
    buffer_load_dwordx4 v[248:251], v3, s[60:63], s5 offen nt
    s_add_u32 s5, s72, 319488
    s_waitcnt vmcnt(3)
    buffer_load_dwordx4 v[252:255], v3, s[60:63], s5 offen nt
    v_lshlrev_b32 v4, 13, v1
    v_lshl_add_u32 v4, v2, 4, v4
    s_and_b32 s75, s3, 3
    v_and_b32 v7, 1, v1
    v_lshlrev_b32 v7, 18, v7
    v_lshrrev_b32 v8, 1, v1
    v_lshl_add_u32 v7, v8, 15, v7
    v_lshrrev_b32 v8, 2, v2
    v_lshl_add_u32 v7, v8, 13, v7
    v_and_b32 v8, 3, v2
    v_lshl_add_u32 v3, v8, 4, v7
    s_lshl_b32 s74, s75, 16
    s_lshl_b32 s6, s71, 7
    s_add_u32 s74, s74, s6
    s_add_u32 s74, s74, 1572864
    s_lshl_b32 s82, s71, 13
    s_add_u32 s82, s82, 1572864
    s_add_u32 s83, s82, 4096
    v_lshrrev_b32 v31, 2, v0
    v_lshlrev_b32 v31, 7, v31
    v_lshl_add_u32 v31, v8, 4, v31
    s_lshr_b32 s70, s71, 5
    s_lshl_b32 s70, s70, 11
    s_bfe_u32 s7, s71, 0x20003
    s_lshl_b32 s7, s7, 8
    s_add_u32 s70, s70, s7
    s_and_b32 s7, s71, 3
    s_lshl_b32 s7, s7, 6
    s_add_u32 s70, s70, s7
    s_and_b32 s7, s71, 4
    s_lshl_b32 s7, s7, 1
    s_add_u32 s70, s70, s7
    s_add_u32 s70, s70, 1024
    s_mov_b32 s48, s38
    s_and_b32 s49, s39, 0xffff
    s_mov_b32 s50, 4096
    s_mov_b32 s51, 0x00020000
    s_cmp_lg_u32 s75, 0
    s_cbranch_scc1 L_nt_1
    buffer_load_dwordx4 v[48:51], v31, s[44:47], s82 offen offset:0 sc1
    buffer_load_dwordx4 v[52:55], v31, s[44:47], s82 offen offset:2048 sc1
    buffer_load_dwordx4 v[56:59], v31, s[44:47], s83 offen offset:0 sc1
    buffer_load_dwordx4 v[60:63], v31, s[44:47], s83 offen offset:2048 sc1
L_nt_1:
    s_lshl_b32 s7, s71, 16
    s_lshl_b32 s80, s75, 8
    s_add_u32 s7, s7, s80
    s_waitcnt vmcnt(3)
    buffer_load_dwordx4 v[160:163], v4, s[64:67], s7 offen offset:0 nt
    s_waitcnt vmcnt(3)
    buffer_load_dwordx4 v[164:167], v4, s[64:67], s7 offen offset:1024 nt
    s_waitcnt vmcnt(3)
    buffer_load_dwordx4 v[168:171], v4, s[64:67], s7 offen offset:2048 nt
    s_waitcnt vmcnt(3)
    buffer_load_dwordx4 v[172:175], v4, s[64:67], s7 offen offset:3072 nt
    s_add_u32 s7, s7, 4096
    s_waitcnt vmcnt(3)
    buffer_load_dwordx4 v[176:179], v4, s[64:67], s7 offen offset:0 nt
    s_waitcnt vmcnt(3)
    buffer_load_dwordx4 v[180:183], v4, s[64:67], s7 offen offset:1024 nt
    s_waitcnt vmcnt(3)
    buffer_load_dwordx4 v[184:187], v4, s[64:67], s7 offen offset:2048 nt
    s_waitcnt vmcnt(3)
    buffer_load_dwordx4 v[188:191], v4, s[64:67], s7 offen offset:3072 nt
    s_add_u32 s7, s7, 28672
    s_waitcnt vmcnt(3)
    buffer_load_dwordx4 v[192:195], v4, s[64:67], s7 offen offset:0 nt
    s_waitcnt vmcnt(3)
    buffer_load_dwordx4 v[196:199], v4, s[64:67], s7 offen offset:1024 nt
    s_waitcnt vmcnt(3)
    buffer_load_dwordx4 v[200:203], v4, s[64:67], s7 offen offset:2048 nt
    s_waitcnt vmcnt(3)
    buffer_load_dwordx4 v[204:207], v4, s[64:67], s7 offen offset:3072 nt
    s_add_u32 s7, s7, 4096
    s_waitcnt vmcnt(3)
    buffer_load_dwordx4 v[208:211], v4, s[64:67], s7 offen offset:0 nt
    s_waitcnt vmcnt(3)
    buffer_load_dwordx4 v[212:215], v4, s[64:67], s7 offen offset:1024 nt
    s_waitcnt vmcnt(3)
    buffer_load_dwordx4 v[216:219], v4, s[64:67], s7 offen offset:2048 nt
    s_waitcnt vmcnt(3)
    buffer_load_dwordx4 v[220:223], v4, s[64:67], s7 offen offset:3072 nt
    s_waitcnt vmcnt(24)
    v_perm_b32 v96, v132, v128, s8
    v_perm_b32 v97, v140, v136, s8
    v_perm_b32 v98, v148, v144, s8
    v_perm_b32 v99, v156, v152, s8
    v_perm_b32 v100, v132, v128, s9
    v_perm_b32 v101, v140, v136, s9
    v_perm_b32 v102, v148, v144, s9
    v_perm_b32 v103, v156, v152, s9
    v_perm_b32 v104, v133, v129, s8
    v_perm_b32 v105, v141, v137, s8
    v_perm_b32 v106, v149, v145, s8
    v_perm_b32 v107, v157, v153, s8
    v_perm_b32 v108, v133, v129, s9
    v_perm_b32 v109, v141, v137, s9
    v_perm_b32 v110, v149, v145, s9
    v_perm_b32 v111, v157, v153, s9
    v_perm_b32 v112, v134, v130, s8
    v_perm_b32 v113, v142, v138, s8
    v_perm_b32 v114, v150, v146, s8
    v_perm_b32 v115, v158, v154, s8
    v_perm_b32 v116, v134, v130, s9
    v_perm_b32 v117, v142, v138, s9
    v_perm_b32 v118, v150, v146, s9
    v_perm_b32 v119, v158, v154, s9
    v_perm_b32 v120, v135, v131, s8
    v_perm_b32 v121, v143, v139, s8
    v_perm_b32 v122, v151, v147, s8
    v_perm_b32 v123, v159, v155, s8
    v_perm_b32 v124, v135, v131, s9
    v_perm_b32 v125, v143, v139, s9
    v_perm_b32 v126, v151, v147, s9
    v_perm_b32 v127, v159, v155, s9
    s_waitcnt vmcnt(8)
    v_perm_b32 v128, v164, v160, s8
    v_perm_b32 v129, v172, v168, s8
    v_perm_b32 v130, v180, v176, s8
    v_perm_b32 v131, v188, v184, s8
    v_perm_b32 v132, v164, v160, s9
    v_perm_b32 v133, v172, v168, s9
    v_perm_b32 v134, v180, v176, s9
    v_perm_b32 v135, v188, v184, s9
    v_perm_b32 v136, v165, v161, s8
    v_perm_b32 v137, v173, v169, s8
    v_perm_b32 v138, v181, v177, s8
    v_perm_b32 v139, v189, v185, s8
    v_perm_b32 v140, v165, v161, s9
    v_perm_b32 v141, v173, v169, s9
    v_perm_b32 v142, v181, v177, s9
    v_perm_b32 v143, v189, v185, s9
    v_perm_b32 v144, v166, v162, s8
    v_perm_b32 v145, v174, v170, s8
    v_perm_b32 v146, v182, v178, s8
    v_perm_b32 v147, v190, v186, s8
    v_perm_b32 v148, v166, v162, s9
    v_perm_b32 v149, v174, v170, s9
    v_perm_b32 v150, v182, v178, s9
    v_perm_b32 v151, v190, v186, s9
    v_perm_b32 v152, v167, v163, s8
    v_perm_b32 v153, v175, v171, s8
    v_perm_b32 v154, v183, v179, s8
    v_perm_b32 v155, v191, v187, s8
    v_perm_b32 v156, v167, v163, s9
    v_perm_b32 v157, v175, v171, s9
    v_perm_b32 v158, v183, v179, s9
    v_perm_b32 v159, v191, v187, s9
    s_waitcnt vmcnt(0)
    v_perm_b32 v160, v196, v192, s8
    v_perm_b32 v161, v204, v200, s8
    v_perm_b32 v162, v212, v208, s8
    v_perm_b32 v163, v220, v216, s8
    v_perm_b32 v164, v196, v192, s9
    v_perm_b32 v165, v204, v200, s9
    v_perm_b32 v166, v212, v208, s9
    v_perm_b32 v167, v220, v216, s9
    v_perm_b32 v168, v197, v193, s8
    v_perm_b32 v169, v205, v201, s8
    v_perm_b32 v170, v213, v209, s8
    v_perm_b32 v171, v221, v217, s8
    v_perm_b32 v172, v197, v193, s9
    v_perm_b32 v173, v205, v201, s9
    v_perm_b32 v174, v213, v209, s9
    v_perm_b32 v175, v221, v217, s9
    v_perm_b32 v176, v198, v194, s8
    v_perm_b32 v177, v206, v202, s8
    v_perm_b32 v178, v214, v210, s8
    v_perm_b32 v179, v222, v218, s8
    v_perm_b32 v180, v198, v194, s9
    v_perm_b32 v181, v206, v202, s9
    v_perm_b32 v182, v214, v210, s9
    v_perm_b32 v183, v222, v218, s9
    v_perm_b32 v184, v199, v195, s8
    v_perm_b32 v185, v207, v203, s8
    v_perm_b32 v186, v215, v211, s8
    v_perm_b32 v187, v223, v219, s8
    v_perm_b32 v188, v199, v195, s9
    v_perm_b32 v189, v207, v203, s9
    v_perm_b32 v190, v215, v211, s9
    v_perm_b32 v191, v223, v219, s9
    v_perm_b32 v192, v228, v224, s8
    v_perm_b32 v193, v236, v232, s8
    v_perm_b32 v194, v244, v240, s8
    v_perm_b32 v195, v252, v248, s8
    v_perm_b32 v196, v228, v224, s9
    v_perm_b32 v197, v236, v232, s9
    v_perm_b32 v198, v244, v240, s9
    v_perm_b32 v199, v252, v248, s9
    v_perm_b32 v200, v229, v225, s8
    v_perm_b32 v201, v237, v233, s8
    v_perm_b32 v202, v245, v241, s8
    v_perm_b32 v203, v253, v249, s8
    v_perm_b32 v204, v229, v225, s9
    v_perm_b32 v205, v237, v233, s9
    v_perm_b32 v206, v245, v241, s9
    v_perm_b32 v207, v253, v249, s9
    v_perm_b32 v208, v230, v226, s8
    v_perm_b32 v209, v238, v234, s8
    v_perm_b32 v210, v246, v242, s8
    v_perm_b32 v211, v254, v250, s8
    v_perm_b32 v212, v230, v226, s9
    v_perm_b32 v213, v238, v234, s9
    v_perm_b32 v214, v246, v242, s9
    v_perm_b32 v215, v254, v250, s9
    v_perm_b32 v216, v231, v227, s8
    v_perm_b32 v217, v239, v235, s8
    v_perm_b32 v218, v247, v243, s8
    v_perm_b32 v219, v255, v251, s8
    v_perm_b32 v220, v231, v227, s9
    v_perm_b32 v221, v239, v235, s9
    v_perm_b32 v222, v247, v243, s9
    v_perm_b32 v223, v255, v251, s9
    v_and_b32 v7, 1, v2
    v_lshlrev_b32 v7, 7, v7
    v_lshl_add_u32 v7, v1, 5, v7
    s_lshl_b32 s5, s68, 9
    s_add_u32 s5, s5, 32768
    v_lshrrev_b32 v8, 3, v2
    v_lshlrev_b32 v9, 20, v8
    v_lshl_add_u32 v9, v1, 13, v9
    v_and_b32 v8, 7, v2
    v_lshl_add_u32 v9, v8, 4, v9
    s_lshl_b32 s76, s68, 15
    s_add_u32 s76, s76, s73
    s_add_u32 s76, s76, 2097152
    s_add_u32 s77, s76, 4096
    v_and_b32 v8, 1, v2
    v_lshlrev_b32 v5, 5, v8
    v_lshl_add_u32 v5, v1, 2, v5
    v_and_b32 v8, 1, v1
    v_lshlrev_b32 v6, 9, v8
    v_lshl_add_u32 v6, v2, 5, v6
    v_lshrrev_b32 v8, 1, v1
    v_lshl_add_u32 v6, v8, 4, v6
    s_lshl_b32 s6, s3, 10
    v_add_u32 v6, s6, v6
    v_lshrrev_b32 v14, 5, v0
    v_lshlrev_b32 v14, 9, v14
    v_and_b32 v8, 31, v0
    v_lshl_add_u32 v14, v8, 3, v14
    s_and_b32 s6, s71, 1
    s_lshl_b32 s6, s6, 8
    v_add_u32 v14, s6, v14
    v_bfe_u32 v30, v2, 2, 1
    v_lshlrev_b32 v30, 7, v30
    v_lshl_add_u32 v30, v1, 4, v30
    s_mov_b32 s11, 20000
    v_lshlrev_b32 v12, 3, v0
    s_cmp_lg_u32 s3, 0
    s_cbranch_scc1 L_H_p3a_d
L_H_p3a:
    buffer_load_dwordx2 v[10:11], v12, s[44:47], s5 offen sc1
    s_waitcnt vmcnt(0)
    v_cmp_ne_u32 vcc, s4, v11
    s_cbranch_vccz L_H_p3c
    s_sleep 1
    s_sub_u32 s11, s11, 1
    s_cmp_gt_i32 s11, 0
    s_cbranch_scc1 L_H_p3a
L_H_p3c:
    v_lshlrev_b32 v12, 2, v0
    ds_write_b32 v12, v10 offset:16384
    s_waitcnt lgkmcnt(0)
L_H_p3a_d:
    s_barrier
    buffer_load_dwordx4 v[224:227], v9, s[44:47], s76 offen offset:0 sc1
    buffer_load_dwordx4 v[228:231], v9, s[44:47], s76 offen offset:1024 sc1
    buffer_load_dwordx4 v[232:235], v9, s[44:47], s76 offen offset:2048 sc1
    buffer_load_dwordx4 v[236:239], v9, s[44:47], s76 offen offset:3072 sc1
    buffer_load_dwordx4 v[240:243], v9, s[44:47], s77 offen offset:0 sc1
    buffer_load_dwordx4 v[244:247], v9, s[44:47], s77 offen offset:1024 sc1
    buffer_load_dwordx4 v[248:251], v9, s[44:47], s77 offen offset:2048 sc1
    buffer_load_dwordx4 v[252:255], v9, s[44:47], s77 offen offset:3072 sc1
    ds_read_b128 v[48:51], v7 offset:16384
    ds_read_b128 v[52:55], v7 offset:16400
    s_waitcnt lgkmcnt(0)
    v_max3_f32 v10, v48, v49, v50
    v_max3_f32 v11, v51, v52, v53
    v_max3_f32 v10, v10, v54, v55
    v_max_f32 v10, v10, v11
    v_mov_b32 v11, v10
    s_nop 1
    v_permlane16_swap_b32 v10, v11
    v_max_f32 v10, v10, v11
    v_mov_b32 v11, v10
    s_nop 1
    v_permlane32_swap_b32 v10, v11
    v_max_f32 v10, v10, v11
    v_sub_f32 v48, v48, v10
    v_sub_f32 v49, v49, v10
    v_sub_f32 v50, v50, v10
    v_sub_f32 v51, v51, v10
    v_sub_f32 v52, v52, v10
    v_sub_f32 v53, v53, v10
    v_sub_f32 v54, v54, v10
    v_sub_f32 v55, v55, v10
    v_exp_f32 v48, v48
    v_exp_f32 v49, v49
    v_exp_f32 v50, v50
    v_exp_f32 v51, v51
    v_exp_f32 v52, v52
    v_exp_f32 v53, v53
    v_exp_f32 v54, v54
    v_exp_f32 v55, v55
    v_cvt_pk_bf16_f32 v16, v48, v49
    v_cvt_pk_bf16_f32 v17, v50, v51
    v_cvt_pk_bf16_f32 v18, v52, v53
    v_cvt_pk_bf16_f32 v19, v54, v55
    v_lshlrev_b32 v48, 16, v16
    v_and_b32 v49, 0xffff0000, v16
    v_lshlrev_b32 v50, 16, v17
    v_and_b32 v51, 0xffff0000, v17
    v_lshlrev_b32 v52, 16, v18
    v_and_b32 v53, 0xffff0000, v18
    v_lshlrev_b32 v54, 16, v19
    v_and_b32 v55, 0xffff0000, v19
    v_add_f32 v48, v48, v49
    v_add_f32 v50, v50, v51
    v_add_f32 v52, v52, v53
    v_add_f32 v54, v54, v55
    v_add_f32 v48, v48, v50
    v_add_f32 v52, v52, v54
    v_add_f32 v10, v48, v52
    v_mov_b32 v11, v10
    s_nop 1
    v_permlane16_swap_b32 v10, v11
    v_add_f32 v10, v10, v11
    v_mov_b32 v11, v10
    s_nop 1
    v_permlane32_swap_b32 v10, v11
    v_add_f32 v10, v10, v11
    v_rcp_f32 v10, v10
    s_nop 0
    v_readlane_b32 s6, v10, 0
    v_readlane_b32 s7, v10, 1
    s_nop 0
    v_mov_b32 v10, s6
    v_mov_b32 v11, s7
    v_cndmask_b32 v10, v10, v11, s[78:79]
    s_waitcnt vmcnt(0)
    v_perm_b32 v64, v228, v224, s8
    v_perm_b32 v65, v236, v232, s8
    v_perm_b32 v66, v244, v240, s8
    v_perm_b32 v67, v252, v248, s8
    v_perm_b32 v68, v228, v224, s9
    v_perm_b32 v69, v236, v232, s9
    v_perm_b32 v70, v244, v240, s9
    v_perm_b32 v71, v252, v248, s9
    v_perm_b32 v72, v229, v225, s8
    v_perm_b32 v73, v237, v233, s8
    v_perm_b32 v74, v245, v241, s8
    v_perm_b32 v75, v253, v249, s8
    v_perm_b32 v76, v229, v225, s9
    v_perm_b32 v77, v237, v233, s9
    v_perm_b32 v78, v245, v241, s9
    v_perm_b32 v79, v253, v249, s9
    v_perm_b32 v80, v230, v226, s8
    v_perm_b32 v81, v238, v234, s8
    v_perm_b32 v82, v246, v242, s8
    v_perm_b32 v83, v254, v250, s8
    v_perm_b32 v84, v230, v226, s9
    v_perm_b32 v85, v238, v234, s9
    v_perm_b32 v86, v246, v242, s9
    v_perm_b32 v87, v254, v250, s9
    v_perm_b32 v88, v231, v227, s8
    v_perm_b32 v89, v239, v235, s8
    v_perm_b32 v90, v247, v243, s8
    v_perm_b32 v91, v255, v251, s8
    v_perm_b32 v92, v231, v227, s9
    v_perm_b32 v93, v239, v235, s9
    v_perm_b32 v94, v247, v243, s9
    v_perm_b32 v95, v255, v251, s9
    v_mfma_f32_16x16x32_bf16 v[32:35], v[16:19], v[64:67], 0
    v_mfma_f32_16x16x32_bf16 v[36:39], v[16:19], v[68:71], 0
    v_mfma_f32_16x16x32_bf16 v[40:43], v[16:19], v[72:75], 0
    v_mfma_f32_16x16x32_bf16 v[44:47], v[16:19], v[76:79], 0
    v_mfma_f32_16x16x32_bf16 v[48:51], v[16:19], v[80:83], 0
    v_mfma_f32_16x16x32_bf16 v[52:55], v[16:19], v[84:87], 0
    v_mfma_f32_16x16x32_bf16 v[56:59], v[16:19], v[88:91], 0
    v_mfma_f32_16x16x32_bf16 v[60:63], v[16:19], v[92:95], 0
    s_nop 0
    v_cndmask_b32 v224, v32, v33, s[78:79]
    v_cndmask_b32 v225, v36, v37, s[78:79]
    v_cndmask_b32 v226, v40, v41, s[78:79]
    v_cndmask_b32 v227, v44, v45, s[78:79]
    v_cndmask_b32 v228, v48, v49, s[78:79]
    v_cndmask_b32 v229, v52, v53, s[78:79]
    v_cndmask_b32 v230, v56, v57, s[78:79]
    v_cndmask_b32 v231, v60, v61, s[78:79]
    v_mul_f32 v224, v224, v10
    v_mul_f32 v225, v225, v10
    v_mul_f32 v226, v226, v10
    v_mul_f32 v227, v227, v10
    v_mul_f32 v228, v228, v10
    v_mul_f32 v229, v229, v10
    v_mul_f32 v230, v230, v10
    v_mul_f32 v231, v231, v10
    v_cvt_pk_bf16_f32 v24, v224, v225
    v_cvt_pk_bf16_f32 v25, v226, v227
    v_cvt_pk_bf16_f32 v26, v228, v229
    v_cvt_pk_bf16_f32 v27, v230, v231
    ds_bpermute_b32 v16, v5, v24 offset:0
    ds_bpermute_b32 v17, v5, v25 offset:0
    ds_bpermute_b32 v18, v5, v26 offset:0
    ds_bpermute_b32 v19, v5, v27 offset:0
    ds_bpermute_b32 v20, v5, v24 offset:16
    ds_bpermute_b32 v21, v5, v25 offset:16
    ds_bpermute_b32 v22, v5, v26 offset:16
    ds_bpermute_b32 v23, v5, v27 offset:16
    s_waitcnt lgkmcnt(4)
    v_mfma_f32_16x16x32_bf16 v[32:35], v[16:19], v[96:99], 0
    v_mfma_f32_16x16x32_bf16 v[36:39], v[16:19], v[100:103], 0
    v_mfma_f32_16x16x32_bf16 v[40:43], v[16:19], v[104:107], 0
    v_mfma_f32_16x16x32_bf16 v[44:47], v[16:19], v[108:111], 0
    v_mfma_f32_16x16x32_bf16 v[48:51], v[16:19], v[112:115], 0
    v_mfma_f32_16x16x32_bf16 v[52:55], v[16:19], v[116:119], 0
    v_mfma_f32_16x16x32_bf16 v[56:59], v[16:19], v[120:123], 0
    v_mfma_f32_16x16x32_bf16 v[60:63], v[16:19], v[124:127], 0
    s_waitcnt lgkmcnt(0)
    v_mfma_f32_16x16x32_bf16 v[32:35], v[20:23], v[192:195], v[32:35]
    v_mfma_f32_16x16x32_bf16 v[36:39], v[20:23], v[196:199], v[36:39]
    v_mfma_f32_16x16x32_bf16 v[40:43], v[20:23], v[200:203], v[40:43]
    v_mfma_f32_16x16x32_bf16 v[44:47], v[20:23], v[204:207], v[44:47]
    v_mfma_f32_16x16x32_bf16 v[48:51], v[20:23], v[208:211], v[48:51]
    v_mfma_f32_16x16x32_bf16 v[52:55], v[20:23], v[212:215], v[52:55]
    v_mfma_f32_16x16x32_bf16 v[56:59], v[20:23], v[216:219], v[56:59]
    v_mfma_f32_16x16x32_bf16 v[60:63], v[20:23], v[220:223], v[60:63]
    s_nop 0
    v_cndmask_b32 v12, v32, v33, s[12:13]
    s_nop 2
    v_cndmask_b32 v13, v48, v49, s[12:13]
    v_cndmask_b32 v8, v12, v13, s[14:15]
    v_cndmask_b32 v12, v36, v37, s[12:13]
    v_cndmask_b32 v13, v52, v53, s[12:13]
    v_cndmask_b32 v9, v12, v13, s[14:15]
    v_cndmask_b32 v12, v40, v41, s[12:13]
    v_cndmask_b32 v13, v56, v57, s[12:13]
    v_cndmask_b32 v10, v12, v13, s[14:15]
    v_cndmask_b32 v12, v44, v45, s[12:13]
    v_cndmask_b32 v13, v60, v61, s[12:13]
    v_cndmask_b32 v11, v12, v13, s[14:15]
    ds_write_b128 v6, v[8:11] offset:8192
    s_waitcnt lgkmcnt(0)
    s_barrier
    ds_read_b64 v[32:33], v14 offset:8192
    ds_read_b64 v[34:35], v14 offset:9216
    ds_read_b64 v[36:37], v14 offset:10240
    ds_read_b64 v[38:39], v14 offset:11264
    ds_read_b64 v[40:41], v14 offset:12288
    ds_read_b64 v[42:43], v14 offset:13312
    ds_read_b64 v[44:45], v14 offset:14336
    ds_read_b64 v[46:47], v14 offset:15360
    s_waitcnt lgkmcnt(4)
    v_pk_add_f32 v[32:33], v[32:33], v[34:35]
    v_pk_add_f32 v[36:37], v[36:37], v[38:39]
    s_waitcnt lgkmcnt(0)
    v_pk_add_f32 v[40:41], v[40:41], v[42:43]
    v_pk_add_f32 v[44:45], v[44:45], v[46:47]
    v_pk_add_f32 v[32:33], v[32:33], v[36:37]
    v_pk_add_f32 v[40:41], v[40:41], v[44:45]
    v_pk_add_f32 v[32:33], v[32:33], v[40:41]
    v_cvt_pk_bf16_f32 v10, v32, v33
    ds_bpermute_b32 v16, v30, v10 offset:0
    ds_bpermute_b32 v17, v30, v10 offset:4
    ds_bpermute_b32 v18, v30, v10 offset:8
    ds_bpermute_b32 v19, v30, v10 offset:12
    ds_bpermute_b32 v20, v30, v10 offset:64
    ds_bpermute_b32 v21, v30, v10 offset:68
    ds_bpermute_b32 v22, v30, v10 offset:72
    ds_bpermute_b32 v23, v30, v10 offset:76
    s_waitcnt lgkmcnt(0)
    v_mov_b32 v52, 1.0
    s_branch L_H_proj
L_T1:
    v_lshlrev_b32 v4, 13, v1
    v_lshl_add_u32 v4, v2, 4, v4
    s_and_b32 s75, s3, 3
    v_and_b32 v7, 1, v1
    v_lshlrev_b32 v7, 18, v7
    v_lshrrev_b32 v8, 1, v1
    v_lshl_add_u32 v7, v8, 15, v7
    v_lshrrev_b32 v8, 2, v2
    v_lshl_add_u32 v7, v8, 13, v7
    v_and_b32 v8, 3, v2
    v_lshl_add_u32 v3, v8, 4, v7
    s_lshl_b32 s74, s75, 16
    s_lshl_b32 s6, s71, 7
    s_add_u32 s74, s74, s6
    s_add_u32 s74, s74, 1048576
    s_lshl_b32 s82, s71, 13
    s_add_u32 s82, s82, 1048576
    s_add_u32 s83, s82, 4096
    v_lshrrev_b32 v31, 2, v0
    v_lshlrev_b32 v31, 7, v31
    v_lshl_add_u32 v31, v8, 4, v31
    s_lshr_b32 s70, s71, 5
    s_lshl_b32 s70, s70, 11
    s_bfe_u32 s7, s71, 0x20003
    s_lshl_b32 s7, s7, 8
    s_add_u32 s70, s70, s7
    s_and_b32 s7, s71, 3
    s_lshl_b32 s7, s7, 6
    s_add_u32 s70, s70, s7
    s_and_b32 s7, s71, 4
    s_lshl_b32 s7, s7, 1
    s_add_u32 s70, s70, s7
    s_add_u32 s70, s70, 0
    s_mov_b32 s48, s38
    s_and_b32 s49, s39, 0xffff
    s_mov_b32 s50, 4096
    s_mov_b32 s51, 0x00020000
    s_mul_i32 s5, s71, 5120
    s_add_u32 s5, s5, 131072
    s_add_u32 s6, s5, 4096
    v_lshlrev_b32 v6, 4, v0
    v_bfe_u32 v9, v2, 2, 1
    v_lshlrev_b32 v9, 6, v9
    v_lshl_add_u32 v9, v1, 3, v9
    s_mov_b32 s11, 20000
    s_waitcnt vmcnt(8)
    v_perm_b32 v128, v68, v64, s8
    v_perm_b32 v129, v76, v72, s8
    v_perm_b32 v130, v84, v80, s8
    v_perm_b32 v131, v92, v88, s8
    v_perm_b32 v132, v68, v64, s9
    v_perm_b32 v133, v76, v72, s9
    v_perm_b32 v134, v84, v80, s9
    v_perm_b32 v135, v92, v88, s9
    v_perm_b32 v136, v69, v65, s8
    v_perm_b32 v137, v77, v73, s8
    v_perm_b32 v138, v85, v81, s8
    v_perm_b32 v139, v93, v89, s8
    v_perm_b32 v140, v69, v65, s9
    v_perm_b32 v141, v77, v73, s9
    v_perm_b32 v142, v85, v81, s9
    v_perm_b32 v143, v93, v89, s9
    v_perm_b32 v144, v70, v66, s8
    v_perm_b32 v145, v78, v74, s8
    v_perm_b32 v146, v86, v82, s8
    v_perm_b32 v147, v94, v90, s8
    v_perm_b32 v148, v70, v66, s9
    v_perm_b32 v149, v78, v74, s9
    v_perm_b32 v150, v86, v82, s9
    v_perm_b32 v151, v94, v90, s9
    v_perm_b32 v152, v71, v67, s8
    v_perm_b32 v153, v79, v75, s8
    v_perm_b32 v154, v87, v83, s8
    v_perm_b32 v155, v95, v91, s8
    v_perm_b32 v156, v71, v67, s9
    v_perm_b32 v157, v79, v75, s9
    v_perm_b32 v158, v87, v83, s9
    v_perm_b32 v159, v95, v91, s9
    s_waitcnt vmcnt(0)
    buffer_load_dwordx4 v[192:195], v6, s[44:47], s5 offen offset:0 sc1
    buffer_load_dwordx4 v[196:199], v6, s[44:47], s5 offen offset:1024 sc1
    buffer_load_dwordx4 v[200:203], v6, s[44:47], s5 offen offset:2048 sc1
    buffer_load_dwordx4 v[204:207], v6, s[44:47], s5 offen offset:3072 sc1
    buffer_load_dwordx4 v[208:211], v6, s[44:47], s6 offen offset:0 sc1
    v_perm_b32 v160, v100, v96, s8
    v_perm_b32 v161, v108, v104, s8
    v_perm_b32 v162, v116, v112, s8
    v_perm_b32 v163, v124, v120, s8
    v_perm_b32 v164, v100, v96, s9
    v_perm_b32 v165, v108, v104, s9
    v_perm_b32 v166, v116, v112, s9
    v_perm_b32 v167, v124, v120, s9
    v_perm_b32 v168, v101, v97, s8
    v_perm_b32 v169, v109, v105, s8
    v_perm_b32 v170, v117, v113, s8
    v_perm_b32 v171, v125, v121, s8
    v_perm_b32 v172, v101, v97, s9
    v_perm_b32 v173, v109, v105, s9
    v_perm_b32 v174, v117, v113, s9
    v_perm_b32 v175, v125, v121, s9
    v_perm_b32 v176, v102, v98, s8
    v_perm_b32 v177, v110, v106, s8
    v_perm_b32 v178, v118, v114, s8
    v_perm_b32 v179, v126, v122, s8
    v_perm_b32 v180, v102, v98, s9
    v_perm_b32 v181, v110, v106, s9
    v_perm_b32 v182, v118, v114, s9
    v_perm_b32 v183, v126, v122, s9
    v_perm_b32 v184, v103, v99, s8
    v_perm_b32 v185, v111, v107, s8
    v_perm_b32 v186, v119, v115, s8
    v_perm_b32 v187, v127, v123, s8
    v_perm_b32 v188, v103, v99, s9
    v_perm_b32 v189, v111, v107, s9
    v_perm_b32 v190, v119, v115, s9
    v_perm_b32 v191, v127, v123, s9
L_H_p4b:
    buffer_load_dwordx4 v[192:195], v6, s[44:47], s5 offen offset:0 sc1
    buffer_load_dwordx4 v[196:199], v6, s[44:47], s5 offen offset:1024 sc1
    buffer_load_dwordx4 v[200:203], v6, s[44:47], s5 offen offset:2048 sc1
    buffer_load_dwordx4 v[204:207], v6, s[44:47], s5 offen offset:3072 sc1
    buffer_load_dwordx4 v[208:211], v6, s[44:47], s6 offen offset:0 sc1
    s_waitcnt vmcnt(5)
    v_bitop3_b32 v24, v192, v193, v194 bitop3:0x96
    v_bitop3_b32 v25, v196, v197, v198 bitop3:0x96
    v_bitop3_b32 v26, v200, v201, v202 bitop3:0x96
    v_bitop3_b32 v27, v204, v205, v206 bitop3:0x96
    v_bitop3_b32 v28, v208, v209, v210 bitop3:0x96
    v_bitop3_b32 v24, v24, v195, s4 bitop3:0x96
    v_bitop3_b32 v25, v25, v199, s4 bitop3:0x96
    v_bitop3_b32 v26, v26, v203, s4 bitop3:0x96
    v_bitop3_b32 v27, v27, v207, s4 bitop3:0x96
    v_bitop3_b32 v28, v28, v211, s4 bitop3:0x96
    v_or3_b32 v12, v24, v25, v26
    v_or3_b32 v12, v12, v27, v28
    v_cmp_ne_u32 vcc, 0, v12
    s_cbranch_vccz L_H_p4d
    s_sleep 2
    s_sub_u32 s11, s11, 1
    s_cmp_gt_i32 s11, 0
    s_cbranch_scc1 L_H_p4b
L_H_p4d:
    v_max3_f32 v10, v194, v198, v202
    v_max3_f32 v10, v10, v206, v210
    v_mov_b32 v11, v10
    v_lshlrev_b32 v216, 16, v192
    v_and_b32 v217, 0xffff0000, v192
    v_permlane32_swap_b32 v10, v11
    v_max_f32 v10, v10, v11
    v_sub_f32 v32, v194, v10
    v_sub_f32 v34, v198, v10
    v_sub_f32 v36, v202, v10
    v_sub_f32 v38, v206, v10
    v_sub_f32 v40, v210, v10
    v_exp_f32 v32, v32
    v_exp_f32 v34, v34
    v_exp_f32 v36, v36
    v_exp_f32 v38, v38
    v_exp_f32 v40, v40
    v_lshlrev_b32 v220, 16, v196
    v_and_b32 v221, 0xffff0000, v196
    v_lshlrev_b32 v224, 16, v200
    v_and_b32 v225, 0xffff0000, v200
    v_lshlrev_b32 v228, 16, v204
    v_and_b32 v229, 0xffff0000, v204
    v_lshlrev_b32 v232, 16, v208
    v_and_b32 v233, 0xffff0000, v208
    v_lshlrev_b32 v218, 16, v193
    v_and_b32 v219, 0xffff0000, v193
    v_lshlrev_b32 v222, 16, v197
    v_and_b32 v223, 0xffff0000, v197
    v_lshlrev_b32 v226, 16, v201
    v_and_b32 v227, 0xffff0000, v201
    v_lshlrev_b32 v230, 16, v205
    v_and_b32 v231, 0xffff0000, v205
    v_lshlrev_b32 v234, 16, v209
    v_and_b32 v235, 0xffff0000, v209
    v_pk_mul_f32 v[48:49], v[216:217], v[32:33] op_sel_hi:[1,0]
    v_pk_mul_f32 v[50:51], v[218:219], v[32:33] op_sel_hi:[1,0]
    v_pk_fma_f32 v[48:49], v[220:221], v[34:35], v[48:49] op_sel_hi:[1,0,1]
    v_pk_fma_f32 v[50:51], v[222:223], v[34:35], v[50:51] op_sel_hi:[1,0,1]
    v_pk_fma_f32 v[48:49], v[224:225], v[36:37], v[48:49] op_sel_hi:[1,0,1]
    v_pk_fma_f32 v[50:51], v[226:227], v[36:37], v[50:51] op_sel_hi:[1,0,1]
    v_pk_fma_f32 v[48:49], v[228:229], v[38:39], v[48:49] op_sel_hi:[1,0,1]
    v_pk_fma_f32 v[50:51], v[230:231], v[38:39], v[50:51] op_sel_hi:[1,0,1]
    v_pk_fma_f32 v[48:49], v[232:233], v[40:41], v[48:49] op_sel_hi:[1,0,1]
    v_pk_fma_f32 v[50:51], v[234:235], v[40:41], v[50:51] op_sel_hi:[1,0,1]
    s_nop 1
    v_permlane32_swap_b32 v48, v50
    v_permlane32_swap_b32 v49, v51
    v_pk_add_f32 v[48:49], v[48:49], v[50:51]
    v_cvt_pk_bf16_f32 v10, v48, v49
    ds_bpermute_b32 v16, v9, v10 offset:0
    ds_bpermute_b32 v17, v9, v10 offset:128
    ds_bpermute_b32 v18, v9, v10 offset:4
    ds_bpermute_b32 v19, v9, v10 offset:132
    ds_bpermute_b32 v20, v9, v10 offset:32
    ds_bpermute_b32 v21, v9, v10 offset:160
    ds_bpermute_b32 v22, v9, v10 offset:36
    ds_bpermute_b32 v23, v9, v10 offset:164
    v_add_f32 v11, v32, v34
    v_add_f32 v12, v36, v38
    v_add_f32 v11, v11, v40
    v_add_f32 v52, v11, v12
    v_mov_b32 v53, v52
    s_nop 1
    v_permlane32_swap_b32 v52, v53
    v_add_f32 v52, v52, v53
    v_rcp_f32 v52, v52
    s_waitcnt lgkmcnt(0)
L_H_proj:
    v_mfma_f32_16x16x32_bf16 v[64:67], v[16:19], v[128:131], 0
    v_mfma_f32_16x16x32_bf16 v[80:83], v[16:19], v[144:147], 0
    v_mfma_f32_16x16x32_bf16 v[68:71], v[16:19], v[132:135], 0
    v_mfma_f32_16x16x32_bf16 v[84:87], v[16:19], v[148:151], 0
    v_mfma_f32_16x16x32_bf16 v[72:75], v[16:19], v[136:139], 0
    v_mfma_f32_16x16x32_bf16 v[88:91], v[16:19], v[152:155], 0
    v_mfma_f32_16x16x32_bf16 v[76:79], v[16:19], v[140:143], 0
    v_mfma_f32_16x16x32_bf16 v[92:95], v[16:19], v[156:159], 0
    v_mfma_f32_16x16x32_bf16 v[64:67], v[20:23], v[160:163], v[64:67]
    v_mfma_f32_16x16x32_bf16 v[80:83], v[20:23], v[176:179], v[80:83]
    v_mfma_f32_16x16x32_bf16 v[68:71], v[20:23], v[164:167], v[68:71]
    v_mfma_f32_16x16x32_bf16 v[84:87], v[20:23], v[180:183], v[84:87]
    v_mfma_f32_16x16x32_bf16 v[72:75], v[20:23], v[168:171], v[72:75]
    v_mfma_f32_16x16x32_bf16 v[88:91], v[20:23], v[184:187], v[88:91]
    v_mfma_f32_16x16x32_bf16 v[76:79], v[20:23], v[172:175], v[76:79]
    v_mfma_f32_16x16x32_bf16 v[92:95], v[20:23], v[188:191], v[92:95]
    v_mov_b32 v13, s4
    v_mov_b32 v15, s4
    v_cndmask_b32 v48, v64, v80, s[14:15]
    s_nop 0
    v_cndmask_b32 v49, v68, v84, s[14:15]
    s_nop 0
    v_cndmask_b32 v50, v72, v88, s[14:15]
    s_nop 0
    v_cndmask_b32 v51, v76, v92, s[14:15]
    v_pk_mul_f32 v[48:49], v[48:49], v[52:53] op_sel_hi:[1,0]
    v_pk_mul_f32 v[50:51], v[50:51], v[52:53] op_sel_hi:[1,0]
    v_cvt_pk_bf16_f32 v12, v48, v49
    v_cvt_pk_bf16_f32 v14, v50, v51
    buffer_store_dwordx4 v[12:15], v3, s[44:47], s74 offen sc1
    s_barrier
    s_cmp_lg_u32 s75, 0
    s_cbranch_scc1 L_H_done
    v_and_b32 v8, 3, v0
    v_lshlrev_b32 v8, 4, v8
    v_lshrrev_b32 v7, 5, v0
    v_lshl_add_u32 v8, v7, 2, v8
    s_mov_b32 s11, 20000
L_H_p6:
    buffer_load_dwordx4 v[96:99], v31, s[44:47], s82 offen offset:0 sc1
    buffer_load_dwordx4 v[100:103], v31, s[44:47], s82 offen offset:2048 sc1
    buffer_load_dwordx4 v[104:107], v31, s[44:47], s83 offen offset:0 sc1
    buffer_load_dwordx4 v[108:111], v31, s[44:47], s83 offen offset:2048 sc1
    s_waitcnt vmcnt(0)
    v_xor_b32 v12, s4, v97
    v_bitop3_b32 v12, v12, v99, s4 bitop3:0xf6
    v_bitop3_b32 v12, v12, v101, s4 bitop3:0xf6
    v_bitop3_b32 v12, v12, v103, s4 bitop3:0xf6
    v_bitop3_b32 v12, v12, v105, s4 bitop3:0xf6
    v_bitop3_b32 v12, v12, v107, s4 bitop3:0xf6
    v_bitop3_b32 v12, v12, v109, s4 bitop3:0xf6
    v_bitop3_b32 v12, v12, v111, s4 bitop3:0xf6
    v_cmp_ne_u32 vcc, 0, v12
    s_cbranch_vccz L_H_p6d
    s_sub_u32 s11, s11, 1
    s_cmp_gt_i32 s11, 0
    s_cbranch_scc1 L_H_p6
L_H_p6d:
    v_lshlrev_b32 v32, 16, v96
    v_and_b32 v33, 0xffff0000, v96
    v_lshlrev_b32 v34, 16, v98
    v_and_b32 v35, 0xffff0000, v98
    v_lshlrev_b32 v36, 16, v100
    v_and_b32 v37, 0xffff0000, v100
    v_lshlrev_b32 v38, 16, v102
    v_and_b32 v39, 0xffff0000, v102
    v_lshlrev_b32 v40, 16, v104
    v_and_b32 v41, 0xffff0000, v104
    v_lshlrev_b32 v42, 16, v106
    v_and_b32 v43, 0xffff0000, v106
    v_lshlrev_b32 v44, 16, v108
    v_and_b32 v45, 0xffff0000, v108
    v_lshlrev_b32 v46, 16, v110
    v_and_b32 v47, 0xffff0000, v110
    v_pk_add_f32 v[32:33], v[32:33], v[36:37]
    v_pk_add_f32 v[40:41], v[40:41], v[44:45]
    v_pk_add_f32 v[34:35], v[34:35], v[38:39]
    v_pk_add_f32 v[42:43], v[42:43], v[46:47]
    v_pk_add_f32 v[32:33], v[32:33], v[40:41]
    v_pk_add_f32 v[34:35], v[34:35], v[42:43]
    s_nop 1
    v_permlane32_swap_b32 v32, v34
    v_permlane32_swap_b32 v33, v35
    v_pk_add_f32 v[32:33], v[32:33], v[34:35]
    v_mov_b32 v34, v32
    v_mov_b32 v35, v33
    s_nop 0
    v_permlane16_swap_b32 v32, v34
    v_permlane16_swap_b32 v33, v35
    v_pk_add_f32 v[32:33], v[32:33], v[34:35]
    s_nop 1
    v_add_f32_dpp v32, v32, v32 row_ror:4 row_mask:0xf bank_mask:0xf
    v_add_f32_dpp v33, v33, v33 row_ror:4 row_mask:0xf bank_mask:0xf
    s_nop 0
    v_add_f32_dpp v32, v32, v32 row_ror:8 row_mask:0xf bank_mask:0xf
    v_add_f32_dpp v33, v33, v33 row_ror:8 row_mask:0xf bank_mask:0xf
    v_cvt_pk_bf16_f32 v10, v32, v33
    s_mov_b32 exec_lo, 15
    s_mov_b32 exec_hi, 15
    buffer_store_dword v10, v8, s[48:51], s70 offen sc1
    s_mov_b64 exec, -1
    s_cmp_lg_u32 s2, 160
    s_cbranch_scc1 L_H_done
    v_mov_b32 v6, s4
    v_mov_b32 v7, 0
    s_mov_b64 exec, 1
    buffer_store_dword v6, v7, s[44:47], 0 offen sc1
    s_mov_b64 exec, -1
L_H_done:
    s_endpgm
L_end:
    s_endpgm
L_codeend:
.section .rodata,"a"
.p2align 6
.amdhsa_kernel concat_heads__gqa_block_cached__compressed_kv_cla__decode_kernel
  .amdhsa_next_free_vgpr 256
  .amdhsa_next_free_sgpr 102
  .amdhsa_accum_offset 256
  .amdhsa_group_segment_fixed_size 0
  .amdhsa_kernarg_size 112
  .amdhsa_user_sgpr_count 2
  .amdhsa_user_sgpr_kernarg_segment_ptr 1
  .amdhsa_system_sgpr_workgroup_id_x 1
.end_amdhsa_kernel
```
